```python
import torch

def _softmax(x, axis=-1):
    return torch.softmax(x, dim=axis)
def _gelu(x):
    return torch.nn.functional.gelu(x, approximate="tanh")
def _silu(x):
    return torch.nn.functional.silu(x)
def _sigmoid(x):
    return torch.sigmoid(x)
def _layernorm(x, axis=-1, eps=1e-5):
    m = x.mean(dim=axis, keepdim=True)
    v = x.var(dim=axis, keepdim=True, unbiased=False)
    return (x - m) / torch.sqrt(v + eps)
def _scatter_add(tgt, idx, src, axis=0):
    return tgt.clone().index_add_(axis, idx, src)
def _segment_sum(src, seg, n):
    out = torch.zeros((n,) + src.shape[1:], dtype=src.dtype)
    return out.index_add_(0, seg, src)
def _pad(x, pw):
    flat = tuple(v for pair in reversed(pw) for v in pair)
    return torch.nn.functional.pad(x, flat)

kernel_name = 'gather_scatter__edge_featured_mpnn_gatedgcn__graph'

def setup_inputs():

    _w = (lambda a: (lambda t: t.to(torch.bfloat16) if t.is_floating_point() else t)(torch.as_tensor(a)))
    N, deg, D, De = 10000, 16, 256, max(0, 1)
    E = N * deg
    return {
        "x": _w((lambda *s: torch.randn(*s, dtype=torch.bfloat16) * 0.4)(N, D)),
        "e_attr": _w((lambda *s: torch.randn(*s, dtype=torch.bfloat16) * 0.8)(E, De)),
        "src": _w((lambda lo, hi, *s: torch.randint(lo, hi, s))(0, N, E).to(torch.int64)),
        "dst": _w((lambda lo, hi, *s: torch.randint(lo, hi, s))(0, N, E).to(torch.int64)),
        "w_a": _w((lambda *s: torch.randn(*s, dtype=torch.bfloat16) * 0.4)(D, D)),
        "w_b": _w((lambda *s: torch.randn(*s, dtype=torch.bfloat16) * 0.4)(D, D)),
        "w_c": _w((lambda *s: torch.randn(*s, dtype=torch.bfloat16) * 0.8)(De, D)),
        "w_u": _w((lambda *s: torch.randn(*s, dtype=torch.bfloat16) * 0.05)(D, D)),
        "w_v": _w((lambda *s: torch.randn(*s, dtype=torch.bfloat16) * 0.05)(D, D)),
    }

def reference(x, e_attr, src, dst, w_a, w_b, w_c, w_u, w_v):
    N, D = x.shape
    hv = x @ w_v
    g = x[dst] @ w_a + x[src] @ w_b + e_attr @ w_c
    eta = _sigmoid(g)
    denom = _segment_sum(eta, dst, N) + 1e-6
    eta_n = eta / denom[dst]
    agg = _segment_sum(eta_n * hv[src], dst, N)
    z = x @ w_u + agg
    relu_z = torch.where(z > 0, z, 0 * z)
    return x + relu_z
```

```asm
; @launch grid=(256,1,1) block=(512,1,1) lds=163840
.amdgcn_target "amdgcn-amd-amdhsa--gfx950"
.text
.globl gather_scatter__edge_featured_mpnn_gatedgcn__graph_kernel
.p2align 8
.type gather_scatter__edge_featured_mpnn_gatedgcn__graph_kernel,@function
gather_scatter__edge_featured_mpnn_gatedgcn__graph_kernel:
  s_cmp_ge_u32 s2, 256
  s_cbranch_scc1 L_end
  s_load_dwordx16 s[16:31], s[0:1], 0
  s_load_dwordx8 s[32:39], s[0:1], 64
  v_and_b32 v1, 63, v0
  v_lshrrev_b32 v2, 6, v0
  v_mov_b32 v248, 0
  v_readfirstlane_b32 s40, v2
  s_getpc_b64 s[12:13]
L_pc:
  s_cmp_lg_u32 s40, 7
  s_cbranch_scc1 L_nopf
  s_lshr_b32 s3, s2, 3
  s_lshl_b32 s3, s3, 10
  v_lshl_add_u32 v2, v1, 4, s3
  v_cmp_gt_u32 vcc, L_codeend-L_pc-16, v2
  s_and_saveexec_b64 s[98:99], vcc
  s_cbranch_execz L_nopf2
  global_load_dwordx4 v[240:243], v2, s[12:13]
L_nopf2:
  s_mov_b64 exec, -1
L_nopf:
  v_lshlrev_b32 v17, 3, v0
  v_mov_b32 v20, 0
  v_mov_b32 v21, 0
  ds_write_b64 v17, v[20:21]
  s_and_b32 s41, s2, 7
  s_lshr_b32 s41, s41, 1
  s_lshr_b32 s42, s2, 3
  s_lshl_b32 s42, s42, 1
  s_and_b32 s92, s2, 1
  s_or_b32 s42, s42, s92
  s_mul_i32 s44, s42, 157
  s_sub_u32 s45, 10000, s44
  s_min_u32 s45, s45, 157
  v_mov_b32 v56, 0
  v_mov_b32 v57, 0
  v_mov_b32 v58, 0
  v_mov_b32 v59, 0
  v_mov_b32 v60, 0
  v_mov_b32 v61, 0
  v_mov_b32 v62, 0
  v_mov_b32 v63, 0
  v_mov_b32 v240, 0
  v_mov_b32 v241, 0
  v_mov_b32 v242, 0
  v_mov_b32 v243, 0
  s_mul_i32 s7, s41, 5
  s_add_u32 s7, s7, 1
  s_lshr_b32 s7, s7, 1
  s_lshr_b32 s9, s2, 3
  s_mov_b32 s10, 0xffffff00
  s_cmp_ge_u32 s40, 4
  s_cbranch_scc1 L_e0
  v_lshrrev_b32 v17, 5, v1
  s_lshl_b32 s92, s40, 1
  v_add_u32 v17, s92, v17
  v_and_b32 v18, 31, v1
  v_and_b32 v19, 15, v17
  v_xor_b32 v22, v18, v19
  v_lshlrev_b32 v22, 4, v22
  v_lshl_add_u32 v22, v17, 9, v22
  v_add_u32 v17, 8, v17
  v_and_b32 v19, 15, v17
  v_xor_b32 v23, v18, v19
  v_lshlrev_b32 v23, 4, v23
  v_lshl_add_u32 v23, v17, 9, v23
  v_lshrrev_b32 v17, 3, v1
  s_lshl_b32 s92, s40, 3
  v_add_u32 v17, s92, v17
  v_bfe_u32 v20, v1, 4, 1
  s_and_b32 s92, s40, 1
  s_lshl_b32 s92, s92, 1
  v_or_b32 v20, s92, v20
  v_bfe_u32 v19, v1, 1, 2
  v_xor_b32 v19, v19, v20
  v_lshlrev_b32 v19, 1, v19
  v_and_b32 v20, 1, v1
  v_or_b32 v19, v19, v20
  v_lshlrev_b32 v19, 4, v19
  v_lshl_add_u32 v19, v17, 9, v19
  s_lshl_b32 s92, s41, 7
  v_add_u32 v249, s92, v19
  s_waitcnt lgkmcnt(0)
  s_barrier
  v_and_b32 v17, 7, v1
  v_lshlrev_b32 v17, 3, v17
  s_lshl_b32 s92, s41, 7
  v_add_u32 v17, s92, v17
  s_mov_b32 s80, s28
  s_mov_b32 s81, s29
  s_mov_b32 s82, 512
  s_mov_b32 s83, 0x20000
  buffer_load_dwordx2 v[250:251], v17, s[80:83], 0 offen
  buffer_load_dwordx2 v[252:253], v17, s[80:83], 0 offen offset:64
  s_mov_b32 s48, s16
  s_mov_b32 s49, s17
  s_mov_b32 s50, 5120000
  s_mov_b32 s51, 0x20000
  s_mov_b32 s64, s26
  s_mov_b32 s65, s27
  s_mov_b32 s66, 131072
  s_mov_b32 s67, 0x20000
  s_mov_b32 s68, s32
  s_mov_b32 s69, s33
  s_mov_b32 s70, 131072
  s_mov_b32 s71, 0x20000
  s_lshl_b32 s94, s40, 10
  s_mov_b32 s8, s7
  s_mov_b32 s6, 0
L_dmaw:
  s_add_u32 s92, s6, s9
  s_and_b32 s92, s92, 7
  s_lshl_b32 s93, s92, 14
  s_lshl_b32 s92, s92, 12
  s_add_u32 s92, s92, s94
  s_add_u32 m0, s92, 86016
  s_nop 0
  buffer_load_dwordx4 v249, s[64:67], s93 offen lds
  s_add_u32 m0, s92, 118784
  s_nop 0
  buffer_load_dwordx4 v249, s[68:71], s93 offen lds
  s_waitcnt vmcnt(8)
  s_add_u32 s6, s6, 1
  s_cmp_lt_u32 s6, 8
  s_cbranch_scc1 L_dmaw
  s_mov_b32 s6, 0
L_dmax1:
  s_lshr_b32 s8, s6, 1
  s_and_b32 s92, s6, 1
  s_mul_i32 s92, s92, 5
  s_add_u32 s8, s8, s92
  s_lshl_b32 s92, s8, 13
  s_add_u32 s95, s92, s94
  s_add_u32 m0, s95, 4096
  s_lshl_b32 s93, s44, 9
  s_add_u32 s93, s93, s92
  buffer_load_dwordx4 v22, s[48:51], s93 offen lds
  s_add_u32 m0, s95, 8192
  s_nop 0
  buffer_load_dwordx4 v23, s[48:51], s93 offen lds
  s_waitcnt vmcnt(8)
  s_add_u32 s6, s6, 1
  s_cmp_lt_u32 s6, 4
  s_cbranch_scc1 L_dmax1
  s_mov_b32 s88, s34
  s_mov_b32 s89, s35
  s_mov_b32 s90, 5120000
  s_mov_b32 s91, 0x20000
  s_mul_i32 s92, s41, 2621440
  s_add_u32 s72, s38, s92
  s_addc_u32 s73, s39, 0
  s_add_u32 s92, s44, s45
  s_lshl_b32 s74, s92, 8
  s_mov_b32 s75, 0x20000
  s_mov_b32 s76, s72
  s_mov_b32 s77, s73
  s_mov_b32 s78, 2560256
  s_mov_b32 s79, 0x20000
  s_add_u32 s84, s38, 12058624
  s_addc_u32 s85, s39, 0
  s_mov_b32 s86, 135168
  s_mov_b32 s87, 0x20000
  s_add_u32 s4, s38, 12255232
  s_addc_u32 s5, s39, 0
  s_load_dword s43, s[4:5], 0
  s_mov_b32 s52, s22
  s_mov_b32 s53, s23
  s_mov_b32 s54, 640000
  s_mov_b32 s55, 0x20000
  s_mov_b32 s56, s20
  s_mov_b32 s57, s21
  s_mov_b32 s58, 640000
  s_mov_b32 s59, 0x20000
  s_mov_b32 s60, s18
  s_mov_b32 s61, s19
  s_mov_b32 s62, 320000
  s_mov_b32 s63, 0x20000
  s_add_u32 s80, s38, 10485760
  s_addc_u32 s81, s39, 0
  s_mov_b32 s82, 1441792
  s_mov_b32 s83, 0x20000
  s_and_b32 s95, s40, 1
  s_lshl_b32 s95, s95, 1
  v_lshrrev_b32 v17, 4, v1
  v_bfe_u32 v18, v1, 2, 2
  v_lshl_add_u32 v19, v17, 3, v18
  v_lshlrev_b32 v19, 7, v19
  v_bfe_u32 v20, v1, 3, 1
  v_and_b32 v21, 1, v17
  v_lshl_or_b32 v20, v21, 1, v20
  v_xor_b32 v20, s95, v20
  v_and_b32 v21, 3, v1
  v_lshl_add_u32 v19, v21, 3, v19
  v_add_u32 v19, 86016, v19
  v_lshl_add_u32 v240, v20, 5, v19
  v_xor_b32 v20, 1, v20
  v_lshl_add_u32 v243, v20, 5, v19
  v_and_b32 v18, 15, v1
  v_and_b32 v19, 12, v18
  v_xor_b32 v19, 0, v19
  v_and_b32 v20, 3, v18
  v_xor_b32 v20, v20, v17
  v_add_u32 v19, v19, v20
  v_lshlrev_b32 v19, 4, v19
  v_lshl_add_u32 v56, v18, 9, v19
  v_add_u32 v56, 4096, v56
  v_and_b32 v19, 12, v18
  v_xor_b32 v19, 4, v19
  v_and_b32 v20, 3, v18
  v_xor_b32 v20, v20, v17
  v_add_u32 v19, v19, v20
  v_lshlrev_b32 v19, 4, v19
  v_lshl_add_u32 v57, v18, 9, v19
  v_add_u32 v57, 4096, v57
  v_and_b32 v19, 12, v18
  v_xor_b32 v19, 8, v19
  v_and_b32 v20, 3, v18
  v_xor_b32 v20, v20, v17
  v_add_u32 v19, v19, v20
  v_lshlrev_b32 v19, 4, v19
  v_lshl_add_u32 v58, v18, 9, v19
  v_add_u32 v58, 4096, v58
  v_and_b32 v19, 12, v18
  v_xor_b32 v19, 12, v19
  v_and_b32 v20, 3, v18
  v_xor_b32 v20, v20, v17
  v_add_u32 v19, v19, v20
  v_lshlrev_b32 v19, 4, v19
  v_lshl_add_u32 v59, v18, 9, v19
  v_add_u32 v59, 4096, v59
  v_lshlrev_b32 v19, 10, v17
  s_lshl_b32 s92, s95, 6
  v_lshl_add_u32 v19, v18, 2, v19
  v_add_u32 v241, s92, v19
  s_lshr_b32 s7, s40, 1
  s_mul_i32 s7, s7, 5
  s_waitcnt vmcnt(8) lgkmcnt(0)
  s_mul_i32 s43, s43, 0x9E3779B1
  s_add_u32 s43, s43, 0x7F4A7C15
  v_mov_b32 v244, 1
  s_mov_b64 exec, 1
  ds_add_u32 v248, v244 offset:3868
  s_mov_b64 exec, -1
  s_mov_b32 s96, 0
L_spin_1:
  ds_read_b32 v244, v248 offset:3868
  s_waitcnt lgkmcnt(0)
  v_readfirstlane_b32 s92, v244
  s_add_u32 s96, s96, 1
  s_cmp_ge_u32 s92, 4
  s_cbranch_scc1 L_spind_2
  s_sleep 1
  s_cmp_lt_u32 s96, 0x40000
  s_cbranch_scc1 L_spin_1
L_spind_2:
  ds_read_b64_tr_b16 v[64:65], v240 offset:0
  ds_read_b64_tr_b16 v[66:67], v240 offset:512
  ds_read_b64_tr_b16 v[68:69], v240 offset:4096
  ds_read_b64_tr_b16 v[70:71], v240 offset:4608
  ds_read_b64_tr_b16 v[72:73], v240 offset:8192
  ds_read_b64_tr_b16 v[74:75], v240 offset:8704
  ds_read_b64_tr_b16 v[76:77], v240 offset:12288
  ds_read_b64_tr_b16 v[78:79], v240 offset:12800
  ds_read_b64_tr_b16 v[80:81], v240 offset:16384
  ds_read_b64_tr_b16 v[82:83], v240 offset:16896
  ds_read_b64_tr_b16 v[84:85], v240 offset:20480
  ds_read_b64_tr_b16 v[86:87], v240 offset:20992
  ds_read_b64_tr_b16 v[88:89], v240 offset:24576
  ds_read_b64_tr_b16 v[90:91], v240 offset:25088
  ds_read_b64_tr_b16 v[92:93], v240 offset:28672
  ds_read_b64_tr_b16 v[94:95], v240 offset:29184
  ds_read_b64_tr_b16 v[96:97], v243 offset:0
  ds_read_b64_tr_b16 v[98:99], v243 offset:512
  ds_read_b64_tr_b16 v[100:101], v243 offset:4096
  ds_read_b64_tr_b16 v[102:103], v243 offset:4608
  ds_read_b64_tr_b16 v[104:105], v243 offset:8192
  ds_read_b64_tr_b16 v[106:107], v243 offset:8704
  ds_read_b64_tr_b16 v[108:109], v243 offset:12288
  ds_read_b64_tr_b16 v[110:111], v243 offset:12800
  ds_read_b64_tr_b16 v[112:113], v243 offset:16384
  ds_read_b64_tr_b16 v[114:115], v243 offset:16896
  ds_read_b64_tr_b16 v[116:117], v243 offset:20480
  ds_read_b64_tr_b16 v[118:119], v243 offset:20992
  ds_read_b64_tr_b16 v[120:121], v243 offset:24576
  ds_read_b64_tr_b16 v[122:123], v243 offset:25088
  ds_read_b64_tr_b16 v[124:125], v243 offset:28672
  ds_read_b64_tr_b16 v[126:127], v243 offset:29184
  ds_read_b64_tr_b16 v[128:129], v240 offset:32768
  ds_read_b64_tr_b16 v[130:131], v240 offset:33280
  ds_read_b64_tr_b16 v[132:133], v240 offset:36864
  ds_read_b64_tr_b16 v[134:135], v240 offset:37376
  ds_read_b64_tr_b16 v[136:137], v240 offset:40960
  ds_read_b64_tr_b16 v[138:139], v240 offset:41472
  ds_read_b64_tr_b16 v[140:141], v240 offset:45056
  ds_read_b64_tr_b16 v[142:143], v240 offset:45568
  ds_read_b64_tr_b16 v[144:145], v240 offset:49152
  ds_read_b64_tr_b16 v[146:147], v240 offset:49664
  ds_read_b64_tr_b16 v[148:149], v240 offset:53248
  ds_read_b64_tr_b16 v[150:151], v240 offset:53760
  ds_read_b64_tr_b16 v[152:153], v240 offset:57344
  ds_read_b64_tr_b16 v[154:155], v240 offset:57856
  ds_read_b64_tr_b16 v[156:157], v240 offset:61440
  ds_read_b64_tr_b16 v[158:159], v240 offset:61952
  ds_read_b64_tr_b16 v[160:161], v243 offset:32768
  ds_read_b64_tr_b16 v[162:163], v243 offset:33280
  ds_read_b64_tr_b16 v[164:165], v243 offset:36864
  ds_read_b64_tr_b16 v[166:167], v243 offset:37376
  ds_read_b64_tr_b16 v[168:169], v243 offset:40960
  ds_read_b64_tr_b16 v[170:171], v243 offset:41472
  ds_read_b64_tr_b16 v[172:173], v243 offset:45056
  ds_read_b64_tr_b16 v[174:175], v243 offset:45568
  ds_read_b64_tr_b16 v[176:177], v243 offset:49152
  ds_read_b64_tr_b16 v[178:179], v243 offset:49664
  ds_read_b64_tr_b16 v[180:181], v243 offset:53248
  ds_read_b64_tr_b16 v[182:183], v243 offset:53760
  ds_read_b64_tr_b16 v[184:185], v243 offset:57344
  ds_read_b64_tr_b16 v[186:187], v243 offset:57856
  ds_read_b64_tr_b16 v[188:189], v243 offset:61440
  ds_read_b64_tr_b16 v[190:191], v243 offset:61952
  s_waitcnt lgkmcnt(0)
  s_lshl_b32 s94, s40, 10
  v_mov_b32 v244, 1
  s_mov_b64 exec, 1
  ds_add_u32 v248, v244 offset:3840
  s_mov_b64 exec, -1
  s_waitcnt vmcnt(0)
  v_mov_b32 v244, 1
  s_mov_b64 exec, 1
  ds_add_u32 v248, v244 offset:3904
  s_mov_b64 exec, -1
  s_mov_b32 s96, 0
L_spin_3:
  ds_read_b32 v244, v248 offset:3904
  s_waitcnt lgkmcnt(0)
  v_readfirstlane_b32 s92, v244
  s_add_u32 s96, s96, 1
  s_cmp_ge_u32 s92, 4
  s_cbranch_scc1 L_spind_4
  s_sleep 1
  s_cmp_lt_u32 s96, 0x40000
  s_cbranch_scc1 L_spin_3
L_spind_4:
  s_branch L_g_gemm
L_e0:
  s_setprio 2
  v_subrev_u32 v14, 256, v0
  s_mul_i32 s92, s2, 625
  v_add_u32 v15, s92, v14
  v_lshlrev_b32 v16, 1, v15
  v_lshlrev_b32 v15, 2, v15
  v_cmp_gt_u32 vcc, 113, v14
  v_add_u32 v18, 2048, v15
  v_add_u32 v19, 1024, v16
  v_mov_b32 v17, 0x40000000
  v_cndmask_b32 v18, v17, v18, vcc
  v_cndmask_b32 v19, v17, v19, vcc
  s_waitcnt lgkmcnt(0)
  s_mov_b32 s52, s22
  s_mov_b32 s53, s23
  s_mov_b32 s54, 640000
  s_mov_b32 s55, 0x20000
  buffer_load_dword v2, v15, s[52:55], 0 offen
  buffer_load_dword v3, v15, s[52:55], 0 offen offset:1024
  buffer_load_dword v4, v18, s[52:55], 0 offen
  s_mov_b32 s56, s20
  s_mov_b32 s57, s21
  s_mov_b32 s58, 640000
  s_mov_b32 s59, 0x20000
  buffer_load_dword v5, v15, s[56:59], 0 offen
  buffer_load_dword v6, v15, s[56:59], 0 offen offset:1024
  buffer_load_dword v7, v18, s[56:59], 0 offen
  s_mov_b32 s60, s18
  s_mov_b32 s61, s19
  s_mov_b32 s62, 320000
  s_mov_b32 s63, 0x20000
  buffer_load_ushort v8, v16, s[60:63], 0 offen
  buffer_load_ushort v9, v16, s[60:63], 0 offen offset:512
  buffer_load_ushort v10, v19, s[60:63], 0 offen
  s_barrier
  v_and_b32 v17, 7, v1
  v_lshlrev_b32 v17, 3, v17
  s_lshl_b32 s92, s41, 7
  v_add_u32 v17, s92, v17
  s_mov_b32 s80, s28
  s_mov_b32 s81, s29
  s_mov_b32 s82, 512
  s_mov_b32 s83, 0x20000
  buffer_load_dwordx2 v[250:251], v17, s[80:83], 0 offen
  buffer_load_dwordx2 v[252:253], v17, s[80:83], 0 offen offset:64
  s_mov_b32 s64, s24
  s_mov_b32 s65, s25
  s_mov_b32 s66, 131072
  s_mov_b32 s67, 0x20000
  s_mov_b32 s68, s30
  s_mov_b32 s69, s31
  s_mov_b32 s70, 131072
  s_mov_b32 s71, 0x20000
  s_lshr_b32 s3, s2, 3
  s_lshl_b32 s3, s3, 12
  v_lshrrev_b32 v17, 3, v1
  v_lshlrev_b32 v17, 9, v17
  v_and_b32 v19, 7, v1
  v_lshl_add_u32 v17, v19, 4, v17
  s_lshl_b32 s92, s41, 7
  v_add_u32 v17, s92, v17
  s_cmp_lg_u32 s40, 4
  s_cbranch_scc1 L_wu_5_a
  buffer_load_dwordx4 v[240:243], v17, s[64:67], s3 offen
L_wu_5_a:
  s_cmp_lg_u32 s40, 5
  s_cbranch_scc1 L_wu_5_b
  buffer_load_dwordx4 v[240:243], v17, s[68:71], s3 offen
L_wu_5_b:
  s_mov_b32 s88, s34
  s_mov_b32 s89, s35
  s_mov_b32 s90, 5120000
  s_mov_b32 s91, 0x20000
  s_mul_i32 s92, s41, 2621440
  s_add_u32 s72, s38, s92
  s_addc_u32 s73, s39, 0
  s_add_u32 s92, s44, s45
  s_lshl_b32 s74, s92, 8
  s_mov_b32 s75, 0x20000
  s_mov_b32 s76, s72
  s_mov_b32 s77, s73
  s_mov_b32 s78, 2560256
  s_mov_b32 s79, 0x20000
  s_add_u32 s84, s38, 12058624
  s_addc_u32 s85, s39, 0
  s_mov_b32 s86, 135168
  s_mov_b32 s87, 0x20000
  s_add_u32 s4, s38, 12255232
  s_addc_u32 s5, s39, 0
  s_load_dword s43, s[4:5], 0
  s_mov_b32 s48, s16
  s_mov_b32 s49, s17
  s_mov_b32 s50, 5120000
  s_mov_b32 s51, 0x20000
  s_add_u32 s80, s38, 10485760
  s_addc_u32 s81, s39, 0
  s_mov_b32 s82, 1441792
  s_mov_b32 s83, 0x20000
  s_sub_u32 s95, s40, 4
  v_lshrrev_b32 v17, 3, v1
  s_lshl_b32 s92, s95, 3
  v_add_u32 v17, s92, v17
  v_bfe_u32 v20, v1, 4, 1
  s_and_b32 s92, s95, 1
  s_lshl_b32 s92, s92, 1
  v_or_b32 v20, s92, v20
  v_bfe_u32 v19, v1, 1, 2
  v_xor_b32 v19, v19, v20
  v_lshlrev_b32 v19, 1, v19
  v_and_b32 v20, 1, v1
  v_or_b32 v19, v19, v20
  v_lshlrev_b32 v19, 4, v19
  v_lshl_add_u32 v19, v17, 9, v19
  s_lshl_b32 s92, s41, 7
  v_add_u32 v249, s92, v19
  v_lshrrev_b32 v17, 5, v1
  s_lshl_b32 s92, s95, 1
  v_add_u32 v17, s92, v17
  v_and_b32 v18, 31, v1
  v_and_b32 v19, 15, v17
  v_xor_b32 v246, v18, v19
  v_lshlrev_b32 v246, 4, v246
  v_lshl_add_u32 v246, v17, 9, v246
  v_add_u32 v17, 8, v17
  v_and_b32 v19, 15, v17
  v_xor_b32 v247, v18, v19
  v_lshlrev_b32 v247, 4, v247
  v_lshl_add_u32 v247, v17, 9, v247
  s_waitcnt vmcnt(2)
  s_mov_b32 s92, 106862
  v_mul_lo_u32 v36, v2, s92
  v_mul_lo_u32 v37, v3, s92
  v_mul_lo_u32 v38, v4, s92
  v_lshrrev_b32 v36, 24, v36
  v_mul_u32_u24 v17, 157, v36
  v_sub_u32 v17, v2, v17
  v_lshl_or_b32 v28, v5, 8, v17
  v_lshlrev_b32 v29, 16, v8
  v_lshlrev_b32 v36, 2, v36
  v_lshrrev_b32 v37, 24, v37
  v_mul_u32_u24 v17, 157, v37
  v_sub_u32 v17, v3, v17
  v_lshl_or_b32 v30, v6, 8, v17
  v_lshlrev_b32 v31, 16, v9
  v_lshlrev_b32 v37, 2, v37
  v_lshrrev_b32 v38, 24, v38
  v_mul_u32_u24 v17, 157, v38
  v_sub_u32 v17, v4, v17
  v_lshl_or_b32 v32, v7, 8, v17
  v_lshlrev_b32 v33, 16, v10
  v_lshlrev_b32 v38, 2, v38
  v_mov_b32 v16, 1
  ds_add_rtn_u32 v24, v36, v16 offset:0
  ds_add_rtn_u32 v25, v37, v16 offset:0
  v_cmpx_gt_u32 vcc, 113, v14
  ds_add_rtn_u32 v26, v38, v16 offset:0
  s_mov_b64 exec, -1
  v_mov_b32 v17, 1
  s_mov_b64 exec, 1
  ds_add_u32 v248, v17 offset:3876
  s_mov_b64 exec, -1
  v_lshlrev_b32 v18, 2, v1
  s_mov_b32 s96, 0
L_spw_6:
  ds_read_b32 v17, v248 offset:3876
  ds_read_b32 v20, v18 offset:0
  s_waitcnt lgkmcnt(0)
  v_readfirstlane_b32 s92, v17
  s_add_u32 s96, s96, 1
  s_cmp_ge_u32 s92, 4
  s_cbranch_scc1 L_spwd_7
  s_cmp_lt_u32 s96, 0x40000
  s_cbranch_scc1 L_spw_6
L_spwd_7:
  s_mul_i32 s43, s43, 0x9E3779B1
  s_add_u32 s43, s43, 0x7F4A7C15
  v_add_u32 v21, 1, v20
  v_and_b32 v21, -2, v21
  v_mov_b32 v22, v21
  s_nop 1
  v_add_u32_dpp v21, v21, v21 row_shr:1 row_mask:0xf bank_mask:0xf
  s_nop 1
  v_add_u32_dpp v21, v21, v21 row_shr:2 row_mask:0xf bank_mask:0xf
  s_nop 1
  v_add_u32_dpp v21, v21, v21 row_shr:4 row_mask:0xf bank_mask:0xf
  s_nop 1
  v_add_u32_dpp v21, v21, v21 row_shr:8 row_mask:0xf bank_mask:0xf
  s_nop 1
  v_add_u32_dpp v21, v21, v21 row_bcast:15 row_mask:0xa bank_mask:0xf
  s_nop 1
  v_add_u32_dpp v21, v21, v21 row_bcast:31 row_mask:0xc bank_mask:0xf
  s_nop 1
  v_sub_u32 v22, v21, v22
  ds_bpermute_b32 v36, v36, v22
  ds_bpermute_b32 v37, v37, v22
  ds_bpermute_b32 v38, v38, v22
  s_waitcnt lgkmcnt(0)
  v_add_lshl_u32 v36, v36, v24, 3
  v_add_lshl_u32 v37, v37, v25, 3
  v_add_lshl_u32 v38, v38, v26, 3
  v_add_u32 v36, 151552, v36
  v_add_u32 v37, 151552, v37
  v_add_u32 v38, 151552, v38
  ds_write_b64 v36, v[28:29]
  ds_write_b64 v37, v[30:31]
  v_cmpx_gt_u32 vcc, 113, v14
  ds_write_b64 v38, v[32:33]
  s_mov_b64 exec, -1
  v_mov_b32 v16, 1
  s_mov_b64 exec, 1
  ds_add_u32 v248, v16 offset:3888
  s_mov_b64 exec, -1
  v_lshlrev_b32 v17, 4, v14
  v_add_u32 v18, 151552, v17
  s_mov_b32 s96, 0
L_spw_8:
  ds_read_b32 v16, v248 offset:3888
  ds_read_b128 v[28:31], v18
  ds_read_b128 v[32:35], v18 offset:4096
  s_waitcnt lgkmcnt(0)
  v_readfirstlane_b32 s92, v16
  s_add_u32 s96, s96, 1
  s_cmp_ge_u32 s92, 4
  s_cbranch_scc1 L_spwd_9
  s_cmp_lt_u32 s96, 0x40000
  s_cbranch_scc1 L_spw_8
L_spwd_9:
  s_mul_i32 s92, s2, 5632
  s_add_u32 s93, s92, 4096
  s_and_b32 s94, s43, 0xffff
  s_lshr_b32 s95, s43, 16
  v_mov_b32 v19, 0xffff0000
  v_and_or_b32 v29, v29, v19, s94
  v_and_or_b32 v31, v31, v19, s95
  v_and_or_b32 v33, v33, v19, s94
  v_and_or_b32 v35, v35, v19, s95
  buffer_store_dwordx4 v[28:31], v17, s[80:83], s92 offen sc1
  v_cmpx_gt_u32 vcc, 96, v14
  buffer_store_dwordx4 v[32:35], v17, s[80:83], s93 offen sc1
  s_mov_b64 exec, -1
  s_cmp_lg_u32 s40, 4
  s_cbranch_scc1 L_nopub_10
  v_lshl_or_b32 v24, v20, 16, v22
  v_mov_b32 v25, s43
  v_lshlrev_b32 v17, 11, v1
  s_lshl_b32 s92, s2, 3
  buffer_store_dwordx2 v[24:25], v17, s[84:87], s92 offen sc1
L_nopub_10:
  s_branch L_eteam_b
L_g_gemm:
  s_lshl_b32 s12, s7, 13
  v_add_u32 v60, s12, v56
  v_add_u32 v61, s12, v57
  v_add_u32 v62, s12, v58
  v_add_u32 v63, s12, v59
  ds_read_b128 v[192:195], v60 offset:0
  ds_read_b128 v[196:199], v61 offset:0
  ds_read_b128 v[200:203], v62 offset:0
  ds_read_b128 v[204:207], v63 offset:0
  ds_read_b128 v[208:211], v60 offset:256
  ds_read_b128 v[212:215], v61 offset:256
  ds_read_b128 v[216:219], v62 offset:256
  ds_read_b128 v[220:223], v63 offset:256
  s_add_u32 s12, s12, 8192
  v_add_u32 v60, s12, v56
  v_add_u32 v61, s12, v57
  v_add_u32 v62, s12, v58
  v_add_u32 v63, s12, v59
  s_waitcnt lgkmcnt(0)
  s_waitcnt lgkmcnt(7)
  v_mfma_f32_16x16x32_bf16 v[224:227], v[192:195], v[64:67], 0
  v_mfma_f32_16x16x32_bf16 v[228:231], v[192:195], v[128:131], 0
  s_waitcnt lgkmcnt(6)
  v_mfma_f32_16x16x32_bf16 v[224:227], v[196:199], v[68:71], v[224:227]
  v_mfma_f32_16x16x32_bf16 v[228:231], v[196:199], v[132:135], v[228:231]
  s_waitcnt lgkmcnt(5)
  v_mfma_f32_16x16x32_bf16 v[224:227], v[200:203], v[72:75], v[224:227]
  v_mfma_f32_16x16x32_bf16 v[228:231], v[200:203], v[136:139], v[228:231]
  s_waitcnt lgkmcnt(4)
  v_mfma_f32_16x16x32_bf16 v[224:227], v[204:207], v[76:79], v[224:227]
  v_mfma_f32_16x16x32_bf16 v[228:231], v[204:207], v[140:143], v[228:231]
  s_waitcnt lgkmcnt(3)
  v_mfma_f32_16x16x32_bf16 v[224:227], v[208:211], v[80:83], v[224:227]
  v_mfma_f32_16x16x32_bf16 v[228:231], v[208:211], v[144:147], v[228:231]
  s_waitcnt lgkmcnt(2)
  v_mfma_f32_16x16x32_bf16 v[224:227], v[212:215], v[84:87], v[224:227]
  v_mfma_f32_16x16x32_bf16 v[228:231], v[212:215], v[148:151], v[228:231]
  s_waitcnt lgkmcnt(1)
  v_mfma_f32_16x16x32_bf16 v[224:227], v[216:219], v[88:91], v[224:227]
  v_mfma_f32_16x16x32_bf16 v[228:231], v[216:219], v[152:155], v[228:231]
  s_waitcnt lgkmcnt(0)
  v_mfma_f32_16x16x32_bf16 v[224:227], v[220:223], v[92:95], v[224:227]
  v_mfma_f32_16x16x32_bf16 v[228:231], v[220:223], v[156:159], v[228:231]
  v_mfma_f32_16x16x32_bf16 v[232:235], v[192:195], v[96:99], 0
  v_mfma_f32_16x16x32_bf16 v[236:239], v[192:195], v[160:163], 0
  ds_read_b128 v[192:195], v60 offset:0
  v_mfma_f32_16x16x32_bf16 v[232:235], v[196:199], v[100:103], v[232:235]
  v_mfma_f32_16x16x32_bf16 v[236:239], v[196:199], v[164:167], v[236:239]
  ds_read_b128 v[196:199], v61 offset:0
  s_add_u32 s12, s12, 8192
  v_mfma_f32_16x16x32_bf16 v[232:235], v[200:203], v[104:107], v[232:235]
  v_mfma_f32_16x16x32_bf16 v[236:239], v[200:203], v[168:171], v[236:239]
  ds_read_b128 v[200:203], v62 offset:0
  v_mfma_f32_16x16x32_bf16 v[232:235], v[204:207], v[108:111], v[232:235]
  v_mfma_f32_16x16x32_bf16 v[236:239], v[204:207], v[172:175], v[236:239]
  ds_read_b128 v[204:207], v63 offset:0
  v_mul_f32 v224, 0xbfb8aa3b, v224
  v_mul_f32 v225, 0xbfb8aa3b, v225
  v_mfma_f32_16x16x32_bf16 v[232:235], v[208:211], v[112:115], v[232:235]
  v_mfma_f32_16x16x32_bf16 v[236:239], v[208:211], v[176:179], v[236:239]
  ds_read_b128 v[208:211], v60 offset:256
  v_mul_f32 v226, 0xbfb8aa3b, v226
  v_mul_f32 v227, 0xbfb8aa3b, v227
  v_mfma_f32_16x16x32_bf16 v[232:235], v[212:215], v[116:119], v[232:235]
  v_mfma_f32_16x16x32_bf16 v[236:239], v[212:215], v[180:183], v[236:239]
  ds_read_b128 v[212:215], v61 offset:256
  v_cvt_pk_bf16_f32 v8, v224, v228
  v_cvt_pk_bf16_f32 v9, v225, v229
  v_mfma_f32_16x16x32_bf16 v[232:235], v[216:219], v[120:123], v[232:235]
  v_mfma_f32_16x16x32_bf16 v[236:239], v[216:219], v[184:187], v[236:239]
  ds_read_b128 v[216:219], v62 offset:256
  v_cvt_pk_bf16_f32 v10, v226, v230
  v_cvt_pk_bf16_f32 v11, v227, v231
  v_mfma_f32_16x16x32_bf16 v[232:235], v[220:223], v[124:127], v[232:235]
  v_mfma_f32_16x16x32_bf16 v[236:239], v[220:223], v[188:191], v[236:239]
  ds_read_b128 v[220:223], v63 offset:256
  v_add_u32 v60, s12, v56
  v_add_u32 v61, s12, v57
  v_add_u32 v62, s12, v58
  v_add_u32 v63, s12, v59
  s_mov_b32 s96, 0
L_spin_11:
  ds_read_b32 v244, v248 offset:3908
  s_waitcnt lgkmcnt(0)
  v_readfirstlane_b32 s92, v244
  s_add_u32 s96, s96, 1
  s_cmp_ge_u32 s92, 4
  s_cbranch_scc1 L_spind_12
  s_sleep 1
  s_cmp_lt_u32 s96, 0x40000
  s_cbranch_scc1 L_spin_11
L_spind_12:
  s_waitcnt lgkmcnt(7)
  v_mfma_f32_16x16x32_bf16 v[224:227], v[192:195], v[64:67], 0
  v_mfma_f32_16x16x32_bf16 v[228:231], v[192:195], v[128:131], 0
  s_waitcnt lgkmcnt(6)
  v_mfma_f32_16x16x32_bf16 v[224:227], v[196:199], v[68:71], v[224:227]
  v_mfma_f32_16x16x32_bf16 v[228:231], v[196:199], v[132:135], v[228:231]
  s_waitcnt lgkmcnt(5)
  v_mfma_f32_16x16x32_bf16 v[224:227], v[200:203], v[72:75], v[224:227]
  v_mfma_f32_16x16x32_bf16 v[228:231], v[200:203], v[136:139], v[228:231]
  s_waitcnt lgkmcnt(4)
  v_mfma_f32_16x16x32_bf16 v[224:227], v[204:207], v[76:79], v[224:227]
  v_mul_f32 v232, 0xbfb8aa3b, v232
  v_mfma_f32_16x16x32_bf16 v[228:231], v[204:207], v[140:143], v[228:231]
  v_mul_f32 v233, 0xbfb8aa3b, v233
  s_waitcnt lgkmcnt(3)
  v_mfma_f32_16x16x32_bf16 v[224:227], v[208:211], v[80:83], v[224:227]
  v_mul_f32 v234, 0xbfb8aa3b, v234
  v_mfma_f32_16x16x32_bf16 v[228:231], v[208:211], v[144:147], v[228:231]
  v_mul_f32 v235, 0xbfb8aa3b, v235
  s_waitcnt lgkmcnt(2)
  v_mfma_f32_16x16x32_bf16 v[224:227], v[212:215], v[84:87], v[224:227]
  v_cvt_pk_bf16_f32 v12, v232, v236
  v_mfma_f32_16x16x32_bf16 v[228:231], v[212:215], v[148:151], v[228:231]
  v_cvt_pk_bf16_f32 v13, v233, v237
  s_waitcnt lgkmcnt(1)
  v_mfma_f32_16x16x32_bf16 v[224:227], v[216:219], v[88:91], v[224:227]
  v_cvt_pk_bf16_f32 v14, v234, v238
  v_mfma_f32_16x16x32_bf16 v[228:231], v[216:219], v[152:155], v[228:231]
  v_cvt_pk_bf16_f32 v15, v235, v239
  s_waitcnt lgkmcnt(0)
  v_mfma_f32_16x16x32_bf16 v[224:227], v[220:223], v[92:95], v[224:227]
  v_mfma_f32_16x16x32_bf16 v[228:231], v[220:223], v[156:159], v[228:231]
  v_mfma_f32_16x16x32_bf16 v[232:235], v[192:195], v[96:99], 0
  v_mfma_f32_16x16x32_bf16 v[236:239], v[192:195], v[160:163], 0
  ds_read_b128 v[192:195], v60 offset:0
  v_mfma_f32_16x16x32_bf16 v[232:235], v[196:199], v[100:103], v[232:235]
  v_mfma_f32_16x16x32_bf16 v[236:239], v[196:199], v[164:167], v[236:239]
  ds_read_b128 v[196:199], v61 offset:0
  s_add_u32 s12, s12, 8192
  v_mfma_f32_16x16x32_bf16 v[232:235], v[200:203], v[104:107], v[232:235]
  v_mfma_f32_16x16x32_bf16 v[236:239], v[200:203], v[168:171], v[236:239]
  ds_read_b128 v[200:203], v62 offset:0
  v_mfma_f32_16x16x32_bf16 v[232:235], v[204:207], v[108:111], v[232:235]
  v_mfma_f32_16x16x32_bf16 v[236:239], v[204:207], v[172:175], v[236:239]
  ds_read_b128 v[204:207], v63 offset:0
  v_mul_f32 v224, 0xbfb8aa3b, v224
  v_mul_f32 v225, 0xbfb8aa3b, v225
  v_mfma_f32_16x16x32_bf16 v[232:235], v[208:211], v[112:115], v[232:235]
  v_mfma_f32_16x16x32_bf16 v[236:239], v[208:211], v[176:179], v[236:239]
  ds_read_b128 v[208:211], v60 offset:256
  v_mul_f32 v226, 0xbfb8aa3b, v226
  v_mul_f32 v227, 0xbfb8aa3b, v227
  v_mfma_f32_16x16x32_bf16 v[232:235], v[212:215], v[116:119], v[232:235]
  v_mfma_f32_16x16x32_bf16 v[236:239], v[212:215], v[180:183], v[236:239]
  ds_read_b128 v[212:215], v61 offset:256
  v_cvt_pk_bf16_f32 v16, v224, v228
  v_cvt_pk_bf16_f32 v17, v225, v229
  v_mfma_f32_16x16x32_bf16 v[232:235], v[216:219], v[120:123], v[232:235]
  v_mfma_f32_16x16x32_bf16 v[236:239], v[216:219], v[184:187], v[236:239]
  ds_read_b128 v[216:219], v62 offset:256
  v_cvt_pk_bf16_f32 v18, v226, v230
  v_cvt_pk_bf16_f32 v19, v227, v231
  v_mfma_f32_16x16x32_bf16 v[232:235], v[220:223], v[124:127], v[232:235]
  v_mfma_f32_16x16x32_bf16 v[236:239], v[220:223], v[188:191], v[236:239]
  ds_read_b128 v[220:223], v63 offset:256
  v_add_u32 v60, s12, v56
  v_add_u32 v61, s12, v57
  v_add_u32 v62, s12, v58
  v_add_u32 v63, s12, v59
  s_mov_b32 s96, 0
L_spin_13:
  ds_read_b32 v244, v248 offset:3912
  s_waitcnt lgkmcnt(0)
  v_readfirstlane_b32 s92, v244
  s_add_u32 s96, s96, 1
  s_cmp_ge_u32 s92, 4
  s_cbranch_scc1 L_spind_14
  s_sleep 1
  s_cmp_lt_u32 s96, 0x40000
  s_cbranch_scc1 L_spin_13
L_spind_14:
  s_waitcnt lgkmcnt(7)
  v_mfma_f32_16x16x32_bf16 v[224:227], v[192:195], v[64:67], 0
  v_mfma_f32_16x16x32_bf16 v[228:231], v[192:195], v[128:131], 0
  s_waitcnt lgkmcnt(6)
  v_mfma_f32_16x16x32_bf16 v[224:227], v[196:199], v[68:71], v[224:227]
  v_mfma_f32_16x16x32_bf16 v[228:231], v[196:199], v[132:135], v[228:231]
  s_waitcnt lgkmcnt(5)
  v_mfma_f32_16x16x32_bf16 v[224:227], v[200:203], v[72:75], v[224:227]
  v_mfma_f32_16x16x32_bf16 v[228:231], v[200:203], v[136:139], v[228:231]
  s_waitcnt lgkmcnt(4)
  v_mfma_f32_16x16x32_bf16 v[224:227], v[204:207], v[76:79], v[224:227]
  v_mul_f32 v232, 0xbfb8aa3b, v232
  v_mfma_f32_16x16x32_bf16 v[228:231], v[204:207], v[140:143], v[228:231]
  v_mul_f32 v233, 0xbfb8aa3b, v233
  s_waitcnt lgkmcnt(3)
  v_mfma_f32_16x16x32_bf16 v[224:227], v[208:211], v[80:83], v[224:227]
  v_mul_f32 v234, 0xbfb8aa3b, v234
  v_mfma_f32_16x16x32_bf16 v[228:231], v[208:211], v[144:147], v[228:231]
  v_mul_f32 v235, 0xbfb8aa3b, v235
  s_waitcnt lgkmcnt(2)
  v_mfma_f32_16x16x32_bf16 v[224:227], v[212:215], v[84:87], v[224:227]
  v_cvt_pk_bf16_f32 v20, v232, v236
  v_mfma_f32_16x16x32_bf16 v[228:231], v[212:215], v[148:151], v[228:231]
  v_cvt_pk_bf16_f32 v21, v233, v237
  s_waitcnt lgkmcnt(1)
  v_mfma_f32_16x16x32_bf16 v[224:227], v[216:219], v[88:91], v[224:227]
  v_cvt_pk_bf16_f32 v22, v234, v238
  v_mfma_f32_16x16x32_bf16 v[228:231], v[216:219], v[152:155], v[228:231]
  v_cvt_pk_bf16_f32 v23, v235, v239
  s_waitcnt lgkmcnt(0)
  v_mfma_f32_16x16x32_bf16 v[224:227], v[220:223], v[92:95], v[224:227]
  v_mfma_f32_16x16x32_bf16 v[228:231], v[220:223], v[156:159], v[228:231]
  v_mfma_f32_16x16x32_bf16 v[232:235], v[192:195], v[96:99], 0
  v_mfma_f32_16x16x32_bf16 v[236:239], v[192:195], v[160:163], 0
  ds_read_b128 v[192:195], v60 offset:0
  v_mfma_f32_16x16x32_bf16 v[232:235], v[196:199], v[100:103], v[232:235]
  v_mfma_f32_16x16x32_bf16 v[236:239], v[196:199], v[164:167], v[236:239]
  ds_read_b128 v[196:199], v61 offset:0
  s_add_u32 s12, s12, 8192
  v_mfma_f32_16x16x32_bf16 v[232:235], v[200:203], v[104:107], v[232:235]
  v_mfma_f32_16x16x32_bf16 v[236:239], v[200:203], v[168:171], v[236:239]
  ds_read_b128 v[200:203], v62 offset:0
  v_mfma_f32_16x16x32_bf16 v[232:235], v[204:207], v[108:111], v[232:235]
  v_mfma_f32_16x16x32_bf16 v[236:239], v[204:207], v[172:175], v[236:239]
  ds_read_b128 v[204:207], v63 offset:0
  v_mul_f32 v224, 0xbfb8aa3b, v224
  v_mul_f32 v225, 0xbfb8aa3b, v225
  v_mfma_f32_16x16x32_bf16 v[232:235], v[208:211], v[112:115], v[232:235]
  v_mfma_f32_16x16x32_bf16 v[236:239], v[208:211], v[176:179], v[236:239]
  ds_read_b128 v[208:211], v60 offset:256
  v_mul_f32 v226, 0xbfb8aa3b, v226
  v_mul_f32 v227, 0xbfb8aa3b, v227
  v_mfma_f32_16x16x32_bf16 v[232:235], v[212:215], v[116:119], v[232:235]
  v_mfma_f32_16x16x32_bf16 v[236:239], v[212:215], v[180:183], v[236:239]
  ds_read_b128 v[212:215], v61 offset:256
  v_cvt_pk_bf16_f32 v24, v224, v228
  v_cvt_pk_bf16_f32 v25, v225, v229
  v_mfma_f32_16x16x32_bf16 v[232:235], v[216:219], v[120:123], v[232:235]
  v_mfma_f32_16x16x32_bf16 v[236:239], v[216:219], v[184:187], v[236:239]
  ds_read_b128 v[216:219], v62 offset:256
  v_cvt_pk_bf16_f32 v26, v226, v230
  v_cvt_pk_bf16_f32 v27, v227, v231
  v_mfma_f32_16x16x32_bf16 v[232:235], v[220:223], v[124:127], v[232:235]
  v_mfma_f32_16x16x32_bf16 v[236:239], v[220:223], v[188:191], v[236:239]
  ds_read_b128 v[220:223], v63 offset:256
  v_add_u32 v60, s12, v56
  v_add_u32 v61, s12, v57
  v_add_u32 v62, s12, v58
  v_add_u32 v63, s12, v59
  s_mov_b32 s96, 0
L_spin_15:
  ds_read_b32 v244, v248 offset:3916
  s_waitcnt lgkmcnt(0)
  v_readfirstlane_b32 s92, v244
  s_add_u32 s96, s96, 1
  s_cmp_ge_u32 s92, 4
  s_cbranch_scc1 L_spind_16
  s_sleep 1
  s_cmp_lt_u32 s96, 0x40000
  s_cbranch_scc1 L_spin_15
L_spind_16:
  s_waitcnt lgkmcnt(7)
  v_mfma_f32_16x16x32_bf16 v[224:227], v[192:195], v[64:67], 0
  v_mfma_f32_16x16x32_bf16 v[228:231], v[192:195], v[128:131], 0
  s_waitcnt lgkmcnt(6)
  v_mfma_f32_16x16x32_bf16 v[224:227], v[196:199], v[68:71], v[224:227]
  v_mfma_f32_16x16x32_bf16 v[228:231], v[196:199], v[132:135], v[228:231]
  s_waitcnt lgkmcnt(5)
  v_mfma_f32_16x16x32_bf16 v[224:227], v[200:203], v[72:75], v[224:227]
  v_mfma_f32_16x16x32_bf16 v[228:231], v[200:203], v[136:139], v[228:231]
  s_waitcnt lgkmcnt(4)
  v_mfma_f32_16x16x32_bf16 v[224:227], v[204:207], v[76:79], v[224:227]
  v_mul_f32 v232, 0xbfb8aa3b, v232
  v_mfma_f32_16x16x32_bf16 v[228:231], v[204:207], v[140:143], v[228:231]
  v_mul_f32 v233, 0xbfb8aa3b, v233
  s_waitcnt lgkmcnt(3)
  v_mfma_f32_16x16x32_bf16 v[224:227], v[208:211], v[80:83], v[224:227]
  v_mul_f32 v234, 0xbfb8aa3b, v234
  v_mfma_f32_16x16x32_bf16 v[228:231], v[208:211], v[144:147], v[228:231]
  v_mul_f32 v235, 0xbfb8aa3b, v235
  s_waitcnt lgkmcnt(2)
  v_mfma_f32_16x16x32_bf16 v[224:227], v[212:215], v[84:87], v[224:227]
  v_cvt_pk_bf16_f32 v28, v232, v236
  v_mfma_f32_16x16x32_bf16 v[228:231], v[212:215], v[148:151], v[228:231]
  v_cvt_pk_bf16_f32 v29, v233, v237
  s_waitcnt lgkmcnt(1)
  v_mfma_f32_16x16x32_bf16 v[224:227], v[216:219], v[88:91], v[224:227]
  v_cvt_pk_bf16_f32 v30, v234, v238
  v_mfma_f32_16x16x32_bf16 v[228:231], v[216:219], v[152:155], v[228:231]
  v_cvt_pk_bf16_f32 v31, v235, v239
  s_waitcnt lgkmcnt(0)
  v_mfma_f32_16x16x32_bf16 v[224:227], v[220:223], v[92:95], v[224:227]
  v_mfma_f32_16x16x32_bf16 v[228:231], v[220:223], v[156:159], v[228:231]
  v_mfma_f32_16x16x32_bf16 v[232:235], v[192:195], v[96:99], 0
  v_mfma_f32_16x16x32_bf16 v[236:239], v[192:195], v[160:163], 0
  ds_read_b128 v[192:195], v60 offset:0
  v_mfma_f32_16x16x32_bf16 v[232:235], v[196:199], v[100:103], v[232:235]
  v_mfma_f32_16x16x32_bf16 v[236:239], v[196:199], v[164:167], v[236:239]
  ds_read_b128 v[196:199], v61 offset:0
  s_add_u32 s12, s12, 8192
  v_mfma_f32_16x16x32_bf16 v[232:235], v[200:203], v[104:107], v[232:235]
  v_mfma_f32_16x16x32_bf16 v[236:239], v[200:203], v[168:171], v[236:239]
  ds_read_b128 v[200:203], v62 offset:0
  v_mfma_f32_16x16x32_bf16 v[232:235], v[204:207], v[108:111], v[232:235]
  v_mfma_f32_16x16x32_bf16 v[236:239], v[204:207], v[172:175], v[236:239]
  ds_read_b128 v[204:207], v63 offset:0
  v_mul_f32 v224, 0xbfb8aa3b, v224
  v_mul_f32 v225, 0xbfb8aa3b, v225
  v_mfma_f32_16x16x32_bf16 v[232:235], v[208:211], v[112:115], v[232:235]
  v_mfma_f32_16x16x32_bf16 v[236:239], v[208:211], v[176:179], v[236:239]
  ds_read_b128 v[208:211], v60 offset:256
  v_mul_f32 v226, 0xbfb8aa3b, v226
  v_mul_f32 v227, 0xbfb8aa3b, v227
  v_mfma_f32_16x16x32_bf16 v[232:235], v[212:215], v[116:119], v[232:235]
  v_mfma_f32_16x16x32_bf16 v[236:239], v[212:215], v[180:183], v[236:239]
  ds_read_b128 v[212:215], v61 offset:256
  v_cvt_pk_bf16_f32 v32, v224, v228
  v_cvt_pk_bf16_f32 v33, v225, v229
  v_mfma_f32_16x16x32_bf16 v[232:235], v[216:219], v[120:123], v[232:235]
  v_mfma_f32_16x16x32_bf16 v[236:239], v[216:219], v[184:187], v[236:239]
  ds_read_b128 v[216:219], v62 offset:256
  v_cvt_pk_bf16_f32 v34, v226, v230
  v_cvt_pk_bf16_f32 v35, v227, v231
  v_mfma_f32_16x16x32_bf16 v[232:235], v[220:223], v[124:127], v[232:235]
  v_mfma_f32_16x16x32_bf16 v[236:239], v[220:223], v[188:191], v[236:239]
  ds_read_b128 v[220:223], v63 offset:256
  s_waitcnt lgkmcnt(7)
  v_mfma_f32_16x16x32_bf16 v[224:227], v[192:195], v[64:67], 0
  v_mfma_f32_16x16x32_bf16 v[228:231], v[192:195], v[128:131], 0
  s_waitcnt lgkmcnt(6)
  v_mfma_f32_16x16x32_bf16 v[224:227], v[196:199], v[68:71], v[224:227]
  v_mfma_f32_16x16x32_bf16 v[228:231], v[196:199], v[132:135], v[228:231]
  s_waitcnt lgkmcnt(5)
  v_mfma_f32_16x16x32_bf16 v[224:227], v[200:203], v[72:75], v[224:227]
  v_mfma_f32_16x16x32_bf16 v[228:231], v[200:203], v[136:139], v[228:231]
  s_waitcnt lgkmcnt(4)
  v_mfma_f32_16x16x32_bf16 v[224:227], v[204:207], v[76:79], v[224:227]
  v_mul_f32 v232, 0xbfb8aa3b, v232
  v_mfma_f32_16x16x32_bf16 v[228:231], v[204:207], v[140:143], v[228:231]
  v_mul_f32 v233, 0xbfb8aa3b, v233
  s_waitcnt lgkmcnt(3)
  v_mfma_f32_16x16x32_bf16 v[224:227], v[208:211], v[80:83], v[224:227]
  v_mul_f32 v234, 0xbfb8aa3b, v234
  v_mfma_f32_16x16x32_bf16 v[228:231], v[208:211], v[144:147], v[228:231]
  v_mul_f32 v235, 0xbfb8aa3b, v235
  s_waitcnt lgkmcnt(2)
  v_mfma_f32_16x16x32_bf16 v[224:227], v[212:215], v[84:87], v[224:227]
  v_cvt_pk_bf16_f32 v36, v232, v236
  v_mfma_f32_16x16x32_bf16 v[228:231], v[212:215], v[148:151], v[228:231]
  v_cvt_pk_bf16_f32 v37, v233, v237
  s_waitcnt lgkmcnt(1)
  v_mfma_f32_16x16x32_bf16 v[224:227], v[216:219], v[88:91], v[224:227]
  v_cvt_pk_bf16_f32 v38, v234, v238
  v_mfma_f32_16x16x32_bf16 v[228:231], v[216:219], v[152:155], v[228:231]
  v_cvt_pk_bf16_f32 v39, v235, v239
  s_waitcnt lgkmcnt(0)
  v_mfma_f32_16x16x32_bf16 v[224:227], v[220:223], v[92:95], v[224:227]
  v_mfma_f32_16x16x32_bf16 v[228:231], v[220:223], v[156:159], v[228:231]
  v_mfma_f32_16x16x32_bf16 v[232:235], v[192:195], v[96:99], 0
  v_mfma_f32_16x16x32_bf16 v[236:239], v[192:195], v[160:163], 0
  v_mfma_f32_16x16x32_bf16 v[232:235], v[196:199], v[100:103], v[232:235]
  v_mfma_f32_16x16x32_bf16 v[236:239], v[196:199], v[164:167], v[236:239]
  s_add_u32 s12, s12, 8192
  v_mfma_f32_16x16x32_bf16 v[232:235], v[200:203], v[104:107], v[232:235]
  v_mfma_f32_16x16x32_bf16 v[236:239], v[200:203], v[168:171], v[236:239]
  v_mfma_f32_16x16x32_bf16 v[232:235], v[204:207], v[108:111], v[232:235]
  v_mfma_f32_16x16x32_bf16 v[236:239], v[204:207], v[172:175], v[236:239]
  v_mul_f32 v224, 0xbfb8aa3b, v224
  v_mul_f32 v225, 0xbfb8aa3b, v225
  v_mfma_f32_16x16x32_bf16 v[232:235], v[208:211], v[112:115], v[232:235]
  v_mfma_f32_16x16x32_bf16 v[236:239], v[208:211], v[176:179], v[236:239]
  v_mul_f32 v226, 0xbfb8aa3b, v226
  v_mul_f32 v227, 0xbfb8aa3b, v227
  v_mfma_f32_16x16x32_bf16 v[232:235], v[212:215], v[116:119], v[232:235]
  v_mfma_f32_16x16x32_bf16 v[236:239], v[212:215], v[180:183], v[236:239]
  v_cvt_pk_bf16_f32 v40, v224, v228
  v_cvt_pk_bf16_f32 v41, v225, v229
  v_mfma_f32_16x16x32_bf16 v[232:235], v[216:219], v[120:123], v[232:235]
  v_mfma_f32_16x16x32_bf16 v[236:239], v[216:219], v[184:187], v[236:239]
  v_cvt_pk_bf16_f32 v42, v226, v230
  v_cvt_pk_bf16_f32 v43, v227, v231
  v_mfma_f32_16x16x32_bf16 v[232:235], v[220:223], v[124:127], v[232:235]
  v_mfma_f32_16x16x32_bf16 v[236:239], v[220:223], v[188:191], v[236:239]
  s_nop 7
  v_mul_f32 v232, 0xbfb8aa3b, v232
  v_mul_f32 v233, 0xbfb8aa3b, v233
  v_mul_f32 v234, 0xbfb8aa3b, v234
  v_mul_f32 v235, 0xbfb8aa3b, v235
  v_cvt_pk_bf16_f32 v44, v232, v236
  v_cvt_pk_bf16_f32 v45, v233, v237
  v_cvt_pk_bf16_f32 v46, v234, v238
  v_cvt_pk_bf16_f32 v47, v235, v239
  s_mov_b32 s96, 0
L_spin_17:
  ds_read_b32 v244, v248 offset:3920
  s_waitcnt lgkmcnt(0)
  v_readfirstlane_b32 s92, v244
  s_add_u32 s96, s96, 1
  s_cmp_ge_u32 s92, 4
  s_cbranch_scc1 L_spind_18
  s_sleep 1
  s_cmp_lt_u32 s96, 0x40000
  s_cbranch_scc1 L_spin_17
L_spind_18:
  ds_read_b64_tr_b16 v[64:65], v240 offset:0
  ds_read_b64_tr_b16 v[66:67], v240 offset:512
  ds_read_b64_tr_b16 v[68:69], v240 offset:4096
  ds_read_b64_tr_b16 v[70:71], v240 offset:4608
  ds_read_b64_tr_b16 v[72:73], v240 offset:8192
  ds_read_b64_tr_b16 v[74:75], v240 offset:8704
  ds_read_b64_tr_b16 v[76:77], v240 offset:12288
  ds_read_b64_tr_b16 v[78:79], v240 offset:12800
  ds_read_b64_tr_b16 v[80:81], v240 offset:16384
  ds_read_b64_tr_b16 v[82:83], v240 offset:16896
  ds_read_b64_tr_b16 v[84:85], v240 offset:20480
  ds_read_b64_tr_b16 v[86:87], v240 offset:20992
  ds_read_b64_tr_b16 v[88:89], v240 offset:24576
  ds_read_b64_tr_b16 v[90:91], v240 offset:25088
  ds_read_b64_tr_b16 v[92:93], v240 offset:28672
  ds_read_b64_tr_b16 v[94:95], v240 offset:29184
  ds_read_b64_tr_b16 v[96:97], v243 offset:0
  ds_read_b64_tr_b16 v[98:99], v243 offset:512
  ds_read_b64_tr_b16 v[100:101], v243 offset:4096
  ds_read_b64_tr_b16 v[102:103], v243 offset:4608
  ds_read_b64_tr_b16 v[104:105], v243 offset:8192
  ds_read_b64_tr_b16 v[106:107], v243 offset:8704
  ds_read_b64_tr_b16 v[108:109], v243 offset:12288
  ds_read_b64_tr_b16 v[110:111], v243 offset:12800
  ds_read_b64_tr_b16 v[112:113], v243 offset:16384
  ds_read_b64_tr_b16 v[114:115], v243 offset:16896
  ds_read_b64_tr_b16 v[116:117], v243 offset:20480
  ds_read_b64_tr_b16 v[118:119], v243 offset:20992
  ds_read_b64_tr_b16 v[120:121], v243 offset:24576
  ds_read_b64_tr_b16 v[122:123], v243 offset:25088
  ds_read_b64_tr_b16 v[124:125], v243 offset:28672
  ds_read_b64_tr_b16 v[126:127], v243 offset:29184
  ds_read_b64_tr_b16 v[128:129], v240 offset:32768
  ds_read_b64_tr_b16 v[130:131], v240 offset:33280
  ds_read_b64_tr_b16 v[132:133], v240 offset:36864
  ds_read_b64_tr_b16 v[134:135], v240 offset:37376
  ds_read_b64_tr_b16 v[136:137], v240 offset:40960
  ds_read_b64_tr_b16 v[138:139], v240 offset:41472
  ds_read_b64_tr_b16 v[140:141], v240 offset:45056
  ds_read_b64_tr_b16 v[142:143], v240 offset:45568
  ds_read_b64_tr_b16 v[144:145], v240 offset:49152
  ds_read_b64_tr_b16 v[146:147], v240 offset:49664
  ds_read_b64_tr_b16 v[148:149], v240 offset:53248
  ds_read_b64_tr_b16 v[150:151], v240 offset:53760
  ds_read_b64_tr_b16 v[152:153], v240 offset:57344
  ds_read_b64_tr_b16 v[154:155], v240 offset:57856
  ds_read_b64_tr_b16 v[156:157], v240 offset:61440
  ds_read_b64_tr_b16 v[158:159], v240 offset:61952
  ds_read_b64_tr_b16 v[160:161], v243 offset:32768
  ds_read_b64_tr_b16 v[162:163], v243 offset:33280
  ds_read_b64_tr_b16 v[164:165], v243 offset:36864
  ds_read_b64_tr_b16 v[166:167], v243 offset:37376
  ds_read_b64_tr_b16 v[168:169], v243 offset:40960
  ds_read_b64_tr_b16 v[170:171], v243 offset:41472
  ds_read_b64_tr_b16 v[172:173], v243 offset:45056
  ds_read_b64_tr_b16 v[174:175], v243 offset:45568
  ds_read_b64_tr_b16 v[176:177], v243 offset:49152
  ds_read_b64_tr_b16 v[178:179], v243 offset:49664
  ds_read_b64_tr_b16 v[180:181], v243 offset:53248
  ds_read_b64_tr_b16 v[182:183], v243 offset:53760
  ds_read_b64_tr_b16 v[184:185], v243 offset:57344
  ds_read_b64_tr_b16 v[186:187], v243 offset:57856
  ds_read_b64_tr_b16 v[188:189], v243 offset:61440
  ds_read_b64_tr_b16 v[190:191], v243 offset:61952
  s_waitcnt lgkmcnt(0)
  v_mov_b32 v244, 1
  s_mov_b64 exec, 1
  ds_add_u32 v248, v244 offset:3844
  s_mov_b64 exec, -1
  s_mov_b32 s96, 0
L_spin_19:
  ds_read_b32 v244, v248 offset:3844
  s_waitcnt lgkmcnt(0)
  v_readfirstlane_b32 s92, v244
  s_add_u32 s96, s96, 1
  s_cmp_ge_u32 s92, 4
  s_cbranch_scc1 L_spind_20
  s_sleep 1
  s_cmp_lt_u32 s96, 0x40000
  s_cbranch_scc1 L_spin_19
L_spind_20:
  s_mov_b32 s96, 0
L_spin_21:
  ds_read_b32 v244, v248 offset:3892
  s_waitcnt lgkmcnt(0)
  v_readfirstlane_b32 s92, v244
  s_add_u32 s96, s96, 1
  s_cmp_ge_u32 s92, 4
  s_cbranch_scc1 L_spind_22
  s_sleep 1
  s_cmp_lt_u32 s96, 0x40000
  s_cbranch_scc1 L_spin_21
L_spind_22:
  s_cmp_lg_u32 s42, 63
  s_cbranch_scc1 L_nodummy_23
  s_cmp_lg_u32 s40, 0
  s_cbranch_scc1 L_nodummy_23
  v_mov_b32 v244, 0x7f7f
  v_lshlrev_b32 v245, 2, v1
  v_add_u32 v245, 2560000, v245
  buffer_store_dword v244, v245, s[76:79], 0 offen sc1
L_nodummy_23:
  s_add_u32 s13, s7, 0
  s_lshl_b32 s13, s13, 4
  s_add_u32 s13, s13, s44
  s_lshl_b32 s13, s13, 8
  s_add_u32 s14, s7, 1
  s_lshl_b32 s14, s14, 4
  s_add_u32 s14, s14, s44
  s_lshl_b32 s14, s14, 8
  s_add_u32 s15, s7, 2
  s_lshl_b32 s15, s15, 4
  s_add_u32 s15, s15, s44
  s_lshl_b32 s15, s15, 8
  s_add_u32 s46, s7, 3
  s_lshl_b32 s46, s46, 4
  s_add_u32 s46, s46, s44
  s_lshl_b32 s46, s46, 8
  s_add_u32 s47, s7, 4
  s_lshl_b32 s47, s47, 4
  s_add_u32 s47, s47, s44
  s_lshl_b32 s47, s47, 8
  s_lshl_b32 s12, s7, 13
  v_add_u32 v60, s12, v56
  v_add_u32 v61, s12, v57
  v_add_u32 v62, s12, v58
  v_add_u32 v63, s12, v59
  ds_read_b128 v[192:195], v60 offset:0
  ds_read_b128 v[196:199], v61 offset:0
  ds_read_b128 v[200:203], v62 offset:0
  ds_read_b128 v[204:207], v63 offset:0
  ds_read_b128 v[208:211], v60 offset:256
  ds_read_b128 v[212:215], v61 offset:256
  ds_read_b128 v[216:219], v62 offset:256
  ds_read_b128 v[220:223], v63 offset:256
  s_add_u32 s12, s12, 8192
  v_add_u32 v60, s12, v56
  v_add_u32 v61, s12, v57
  v_add_u32 v62, s12, v58
  v_add_u32 v63, s12, v59
  s_lshl_b32 s92, s7, 12
  s_add_u32 s92, s92, 86016
  v_add_u32 v242, s92, v241
  s_waitcnt lgkmcnt(0)
  v_mfma_f32_16x16x32_bf16 v[224:227], v[192:195], v[64:67], 0
  buffer_store_dword v8, v241, s[72:75], s13 offen offset:0 sc1
  v_mfma_f32_16x16x32_bf16 v[228:231], v[192:195], v[128:131], 0
  v_mfma_f32_16x16x32_bf16 v[224:227], v[196:199], v[68:71], v[224:227]
  buffer_store_dword v9, v241, s[72:75], s13 offen offset:256 sc1
  v_mfma_f32_16x16x32_bf16 v[228:231], v[196:199], v[132:135], v[228:231]
  v_mfma_f32_16x16x32_bf16 v[224:227], v[200:203], v[72:75], v[224:227]
  buffer_store_dword v10, v241, s[72:75], s13 offen offset:512 sc1
  v_mfma_f32_16x16x32_bf16 v[228:231], v[200:203], v[136:139], v[228:231]
  v_mfma_f32_16x16x32_bf16 v[224:227], v[204:207], v[76:79], v[224:227]
  buffer_store_dword v11, v241, s[72:75], s13 offen offset:768 sc1
  v_mfma_f32_16x16x32_bf16 v[228:231], v[204:207], v[140:143], v[228:231]
  v_mfma_f32_16x16x32_bf16 v[224:227], v[208:211], v[80:83], v[224:227]
  buffer_store_dword v12, v241, s[72:75], s13 offen offset:64 sc1
  v_mfma_f32_16x16x32_bf16 v[228:231], v[208:211], v[144:147], v[228:231]
  v_mfma_f32_16x16x32_bf16 v[224:227], v[212:215], v[84:87], v[224:227]
  buffer_store_dword v13, v241, s[72:75], s13 offen offset:320 sc1
  v_mfma_f32_16x16x32_bf16 v[228:231], v[212:215], v[148:151], v[228:231]
  v_mfma_f32_16x16x32_bf16 v[224:227], v[216:219], v[88:91], v[224:227]
  buffer_store_dword v14, v241, s[72:75], s13 offen offset:576 sc1
  v_mfma_f32_16x16x32_bf16 v[228:231], v[216:219], v[152:155], v[228:231]
  v_mfma_f32_16x16x32_bf16 v[224:227], v[220:223], v[92:95], v[224:227]
  buffer_store_dword v15, v241, s[72:75], s13 offen offset:832 sc1
  v_mfma_f32_16x16x32_bf16 v[228:231], v[220:223], v[156:159], v[228:231]
  v_mfma_f32_16x16x32_bf16 v[232:235], v[192:195], v[96:99], 0
  v_mfma_f32_16x16x32_bf16 v[236:239], v[192:195], v[160:163], 0
  ds_read_b128 v[192:195], v60 offset:0
  buffer_store_dword v16, v241, s[72:75], s14 offen offset:0 sc1
  v_mfma_f32_16x16x32_bf16 v[232:235], v[196:199], v[100:103], v[232:235]
  v_mfma_f32_16x16x32_bf16 v[236:239], v[196:199], v[164:167], v[236:239]
  ds_read_b128 v[196:199], v61 offset:0
  s_add_u32 s12, s12, 8192
  buffer_store_dword v17, v241, s[72:75], s14 offen offset:256 sc1
  v_mfma_f32_16x16x32_bf16 v[232:235], v[200:203], v[104:107], v[232:235]
  v_mfma_f32_16x16x32_bf16 v[236:239], v[200:203], v[168:171], v[236:239]
  ds_read_b128 v[200:203], v62 offset:0
  buffer_store_dword v18, v241, s[72:75], s14 offen offset:512 sc1
  v_mfma_f32_16x16x32_bf16 v[232:235], v[204:207], v[108:111], v[232:235]
  v_mfma_f32_16x16x32_bf16 v[236:239], v[204:207], v[172:175], v[236:239]
  ds_read_b128 v[204:207], v63 offset:0
  v_mul_f32 v224, 0xbfb8aa3b, v224
  v_mul_f32 v225, 0xbfb8aa3b, v225
  v_mul_f32 v226, 0xbfb8aa3b, v226
  buffer_store_dword v19, v241, s[72:75], s14 offen offset:768 sc1
  v_mfma_f32_16x16x32_bf16 v[232:235], v[208:211], v[112:115], v[232:235]
  v_mfma_f32_16x16x32_bf16 v[236:239], v[208:211], v[176:179], v[236:239]
  ds_read_b128 v[208:211], v60 offset:256
  v_mul_f32 v227, 0xbfb8aa3b, v227
  v_cvt_pk_bf16_f32 v224, v224, v228
  v_cvt_pk_bf16_f32 v225, v225, v229
  buffer_store_dword v20, v241, s[72:75], s14 offen offset:64 sc1
  v_mfma_f32_16x16x32_bf16 v[232:235], v[212:215], v[116:119], v[232:235]
  v_mfma_f32_16x16x32_bf16 v[236:239], v[212:215], v[180:183], v[236:239]
  ds_read_b128 v[212:215], v61 offset:256
  v_cvt_pk_bf16_f32 v226, v226, v230
  v_cvt_pk_bf16_f32 v227, v227, v231
  ds_write_b32 v242, v224 offset:0
  buffer_store_dword v21, v241, s[72:75], s14 offen offset:320 sc1
  v_mfma_f32_16x16x32_bf16 v[232:235], v[216:219], v[120:123], v[232:235]
  v_mfma_f32_16x16x32_bf16 v[236:239], v[216:219], v[184:187], v[236:239]
  ds_read_b128 v[216:219], v62 offset:256
  ds_write_b32 v242, v225 offset:256
  ds_write_b32 v242, v226 offset:512
  buffer_store_dword v22, v241, s[72:75], s14 offen offset:576 sc1
  v_mfma_f32_16x16x32_bf16 v[232:235], v[220:223], v[124:127], v[232:235]
  v_mfma_f32_16x16x32_bf16 v[236:239], v[220:223], v[188:191], v[236:239]
  ds_read_b128 v[220:223], v63 offset:256
  ds_write_b32 v242, v227 offset:768
  buffer_store_dword v23, v241, s[72:75], s14 offen offset:832 sc1
  v_add_u32 v60, s12, v56
  v_add_u32 v61, s12, v57
  v_add_u32 v62, s12, v58
  v_add_u32 v63, s12, v59
  s_waitcnt lgkmcnt(11)
  v_mfma_f32_16x16x32_bf16 v[224:227], v[192:195], v[64:67], 0
  buffer_store_dword v24, v241, s[72:75], s15 offen offset:0 sc1
  v_mfma_f32_16x16x32_bf16 v[228:231], v[192:195], v[128:131], 0
  s_waitcnt lgkmcnt(10)
  v_mfma_f32_16x16x32_bf16 v[224:227], v[196:199], v[68:71], v[224:227]
  buffer_store_dword v25, v241, s[72:75], s15 offen offset:256 sc1
  v_mfma_f32_16x16x32_bf16 v[228:231], v[196:199], v[132:135], v[228:231]
  s_waitcnt lgkmcnt(9)
  v_mfma_f32_16x16x32_bf16 v[224:227], v[200:203], v[72:75], v[224:227]
  buffer_store_dword v26, v241, s[72:75], s15 offen offset:512 sc1
  v_mfma_f32_16x16x32_bf16 v[228:231], v[200:203], v[136:139], v[228:231]
  s_waitcnt lgkmcnt(8)
  v_mfma_f32_16x16x32_bf16 v[224:227], v[204:207], v[76:79], v[224:227]
  v_mul_f32 v232, 0xbfb8aa3b, v232
  v_mul_f32 v233, 0xbfb8aa3b, v233
  v_mfma_f32_16x16x32_bf16 v[228:231], v[204:207], v[140:143], v[228:231]
  v_mul_f32 v234, 0xbfb8aa3b, v234
  buffer_store_dword v27, v241, s[72:75], s15 offen offset:768 sc1
  s_waitcnt lgkmcnt(7)
  v_mfma_f32_16x16x32_bf16 v[224:227], v[208:211], v[80:83], v[224:227]
  v_mul_f32 v235, 0xbfb8aa3b, v235
  v_cvt_pk_bf16_f32 v232, v232, v236
  v_mfma_f32_16x16x32_bf16 v[228:231], v[208:211], v[144:147], v[228:231]
  v_cvt_pk_bf16_f32 v233, v233, v237
  buffer_store_dword v28, v241, s[72:75], s15 offen offset:64 sc1
  s_waitcnt lgkmcnt(6)
  v_mfma_f32_16x16x32_bf16 v[224:227], v[212:215], v[84:87], v[224:227]
  v_cvt_pk_bf16_f32 v234, v234, v238
  v_cvt_pk_bf16_f32 v235, v235, v239
  v_mfma_f32_16x16x32_bf16 v[228:231], v[212:215], v[148:151], v[228:231]
  ds_write_b32 v242, v232 offset:64
  buffer_store_dword v29, v241, s[72:75], s15 offen offset:320 sc1
  s_waitcnt lgkmcnt(5)
  v_mfma_f32_16x16x32_bf16 v[224:227], v[216:219], v[88:91], v[224:227]
  ds_write_b32 v242, v233 offset:320
  ds_write_b32 v242, v234 offset:576
  v_mfma_f32_16x16x32_bf16 v[228:231], v[216:219], v[152:155], v[228:231]
  buffer_store_dword v30, v241, s[72:75], s15 offen offset:576 sc1
  s_waitcnt lgkmcnt(4)
  v_mfma_f32_16x16x32_bf16 v[224:227], v[220:223], v[92:95], v[224:227]
  ds_write_b32 v242, v235 offset:832
  v_mfma_f32_16x16x32_bf16 v[228:231], v[220:223], v[156:159], v[228:231]
  buffer_store_dword v31, v241, s[72:75], s15 offen offset:832 sc1
  v_mfma_f32_16x16x32_bf16 v[232:235], v[192:195], v[96:99], 0
  v_mfma_f32_16x16x32_bf16 v[236:239], v[192:195], v[160:163], 0
  ds_read_b128 v[192:195], v60 offset:0
  buffer_store_dword v32, v241, s[72:75], s46 offen offset:0 sc1
  v_mfma_f32_16x16x32_bf16 v[232:235], v[196:199], v[100:103], v[232:235]
  v_mfma_f32_16x16x32_bf16 v[236:239], v[196:199], v[164:167], v[236:239]
  ds_read_b128 v[196:199], v61 offset:0
  s_add_u32 s12, s12, 8192
  buffer_store_dword v33, v241, s[72:75], s46 offen offset:256 sc1
  v_mfma_f32_16x16x32_bf16 v[232:235], v[200:203], v[104:107], v[232:235]
  v_mfma_f32_16x16x32_bf16 v[236:239], v[200:203], v[168:171], v[236:239]
  ds_read_b128 v[200:203], v62 offset:0
  buffer_store_dword v34, v241, s[72:75], s46 offen offset:512 sc1
  v_mfma_f32_16x16x32_bf16 v[232:235], v[204:207], v[108:111], v[232:235]
  v_mfma_f32_16x16x32_bf16 v[236:239], v[204:207], v[172:175], v[236:239]
  ds_read_b128 v[204:207], v63 offset:0
  v_mul_f32 v224, 0xbfb8aa3b, v224
  v_mul_f32 v225, 0xbfb8aa3b, v225
  v_mul_f32 v226, 0xbfb8aa3b, v226
  buffer_store_dword v35, v241, s[72:75], s46 offen offset:768 sc1
  v_mfma_f32_16x16x32_bf16 v[232:235], v[208:211], v[112:115], v[232:235]
  v_mfma_f32_16x16x32_bf16 v[236:239], v[208:211], v[176:179], v[236:239]
  ds_read_b128 v[208:211], v60 offset:256
  v_mul_f32 v227, 0xbfb8aa3b, v227
  v_cvt_pk_bf16_f32 v224, v224, v228
  v_cvt_pk_bf16_f32 v225, v225, v229
  buffer_store_dword v36, v241, s[72:75], s46 offen offset:64 sc1
  v_mfma_f32_16x16x32_bf16 v[232:235], v[212:215], v[116:119], v[232:235]
  v_mfma_f32_16x16x32_bf16 v[236:239], v[212:215], v[180:183], v[236:239]
  ds_read_b128 v[212:215], v61 offset:256
  v_cvt_pk_bf16_f32 v226, v226, v230
  v_cvt_pk_bf16_f32 v227, v227, v231
  ds_write_b32 v242, v224 offset:4096
  buffer_store_dword v37, v241, s[72:75], s46 offen offset:320 sc1
  v_mfma_f32_16x16x32_bf16 v[232:235], v[216:219], v[120:123], v[232:235]
  v_mfma_f32_16x16x32_bf16 v[236:239], v[216:219], v[184:187], v[236:239]
  ds_read_b128 v[216:219], v62 offset:256
  ds_write_b32 v242, v225 offset:4352
  ds_write_b32 v242, v226 offset:4608
  buffer_store_dword v38, v241, s[72:75], s46 offen offset:576 sc1
  v_mfma_f32_16x16x32_bf16 v[232:235], v[220:223], v[124:127], v[232:235]
  v_mfma_f32_16x16x32_bf16 v[236:239], v[220:223], v[188:191], v[236:239]
  ds_read_b128 v[220:223], v63 offset:256
  ds_write_b32 v242, v227 offset:4864
  buffer_store_dword v39, v241, s[72:75], s46 offen offset:832 sc1
  v_add_u32 v60, s12, v56
  v_add_u32 v61, s12, v57
  v_add_u32 v62, s12, v58
  v_add_u32 v63, s12, v59
  s_waitcnt lgkmcnt(11)
  v_mfma_f32_16x16x32_bf16 v[224:227], v[192:195], v[64:67], 0
  buffer_store_dword v40, v241, s[72:75], s47 offen offset:0 sc1
  v_mfma_f32_16x16x32_bf16 v[228:231], v[192:195], v[128:131], 0
  s_waitcnt lgkmcnt(10)
  v_mfma_f32_16x16x32_bf16 v[224:227], v[196:199], v[68:71], v[224:227]
  buffer_store_dword v41, v241, s[72:75], s47 offen offset:256 sc1
  v_mfma_f32_16x16x32_bf16 v[228:231], v[196:199], v[132:135], v[228:231]
  s_waitcnt lgkmcnt(9)
  v_mfma_f32_16x16x32_bf16 v[224:227], v[200:203], v[72:75], v[224:227]
  buffer_store_dword v42, v241, s[72:75], s47 offen offset:512 sc1
  v_mfma_f32_16x16x32_bf16 v[228:231], v[200:203], v[136:139], v[228:231]
  s_waitcnt lgkmcnt(8)
  v_mfma_f32_16x16x32_bf16 v[224:227], v[204:207], v[76:79], v[224:227]
  v_mul_f32 v232, 0xbfb8aa3b, v232
  v_mul_f32 v233, 0xbfb8aa3b, v233
  v_mfma_f32_16x16x32_bf16 v[228:231], v[204:207], v[140:143], v[228:231]
  v_mul_f32 v234, 0xbfb8aa3b, v234
  buffer_store_dword v43, v241, s[72:75], s47 offen offset:768 sc1
  s_waitcnt lgkmcnt(7)
  v_mfma_f32_16x16x32_bf16 v[224:227], v[208:211], v[80:83], v[224:227]
  v_mul_f32 v235, 0xbfb8aa3b, v235
  v_cvt_pk_bf16_f32 v232, v232, v236
  v_mfma_f32_16x16x32_bf16 v[228:231], v[208:211], v[144:147], v[228:231]
  v_cvt_pk_bf16_f32 v233, v233, v237
  buffer_store_dword v44, v241, s[72:75], s47 offen offset:64 sc1
  s_waitcnt lgkmcnt(6)
  v_mfma_f32_16x16x32_bf16 v[224:227], v[212:215], v[84:87], v[224:227]
  v_cvt_pk_bf16_f32 v234, v234, v238
  v_cvt_pk_bf16_f32 v235, v235, v239
  v_mfma_f32_16x16x32_bf16 v[228:231], v[212:215], v[148:151], v[228:231]
  ds_write_b32 v242, v232 offset:4160
  buffer_store_dword v45, v241, s[72:75], s47 offen offset:320 sc1
  s_waitcnt lgkmcnt(5)
  v_mfma_f32_16x16x32_bf16 v[224:227], v[216:219], v[88:91], v[224:227]
  ds_write_b32 v242, v233 offset:4416
  ds_write_b32 v242, v234 offset:4672
  v_mfma_f32_16x16x32_bf16 v[228:231], v[216:219], v[152:155], v[228:231]
  buffer_store_dword v46, v241, s[72:75], s47 offen offset:576 sc1
  s_waitcnt lgkmcnt(4)
  v_mfma_f32_16x16x32_bf16 v[224:227], v[220:223], v[92:95], v[224:227]
  ds_write_b32 v242, v235 offset:4928
  v_mfma_f32_16x16x32_bf16 v[228:231], v[220:223], v[156:159], v[228:231]
  buffer_store_dword v47, v241, s[72:75], s47 offen offset:832 sc1
  v_mfma_f32_16x16x32_bf16 v[232:235], v[192:195], v[96:99], 0
  v_mfma_f32_16x16x32_bf16 v[236:239], v[192:195], v[160:163], 0
  ds_read_b128 v[192:195], v60 offset:0
  v_mfma_f32_16x16x32_bf16 v[232:235], v[196:199], v[100:103], v[232:235]
  v_mfma_f32_16x16x32_bf16 v[236:239], v[196:199], v[164:167], v[236:239]
  ds_read_b128 v[196:199], v61 offset:0
  s_add_u32 s12, s12, 8192
  v_mfma_f32_16x16x32_bf16 v[232:235], v[200:203], v[104:107], v[232:235]
  v_mfma_f32_16x16x32_bf16 v[236:239], v[200:203], v[168:171], v[236:239]
  ds_read_b128 v[200:203], v62 offset:0
  v_mfma_f32_16x16x32_bf16 v[232:235], v[204:207], v[108:111], v[232:235]
  v_mfma_f32_16x16x32_bf16 v[236:239], v[204:207], v[172:175], v[236:239]
  ds_read_b128 v[204:207], v63 offset:0
  v_mul_f32 v224, 0xbfb8aa3b, v224
  v_mul_f32 v225, 0xbfb8aa3b, v225
  v_mul_f32 v226, 0xbfb8aa3b, v226
  v_mfma_f32_16x16x32_bf16 v[232:235], v[208:211], v[112:115], v[232:235]
  v_mfma_f32_16x16x32_bf16 v[236:239], v[208:211], v[176:179], v[236:239]
  ds_read_b128 v[208:211], v60 offset:256
  v_mul_f32 v227, 0xbfb8aa3b, v227
  v_cvt_pk_bf16_f32 v224, v224, v228
  v_cvt_pk_bf16_f32 v225, v225, v229
  v_mfma_f32_16x16x32_bf16 v[232:235], v[212:215], v[116:119], v[232:235]
  v_mfma_f32_16x16x32_bf16 v[236:239], v[212:215], v[180:183], v[236:239]
  ds_read_b128 v[212:215], v61 offset:256
  v_cvt_pk_bf16_f32 v226, v226, v230
  v_cvt_pk_bf16_f32 v227, v227, v231
  ds_write_b32 v242, v224 offset:8192
  v_mfma_f32_16x16x32_bf16 v[232:235], v[216:219], v[120:123], v[232:235]
  v_mfma_f32_16x16x32_bf16 v[236:239], v[216:219], v[184:187], v[236:239]
  ds_read_b128 v[216:219], v62 offset:256
  ds_write_b32 v242, v225 offset:8448
  ds_write_b32 v242, v226 offset:8704
  v_mfma_f32_16x16x32_bf16 v[232:235], v[220:223], v[124:127], v[232:235]
  v_mfma_f32_16x16x32_bf16 v[236:239], v[220:223], v[188:191], v[236:239]
  ds_read_b128 v[220:223], v63 offset:256
  ds_write_b32 v242, v227 offset:8960
  v_add_u32 v60, s12, v56
  v_add_u32 v61, s12, v57
  v_add_u32 v62, s12, v58
  v_add_u32 v63, s12, v59
  s_waitcnt vmcnt(0)
  v_mov_b32 v244, 1
  s_mov_b64 exec, 1
  ds_add_rtn_u32 v244, v248, v244 offset:3848
  s_waitcnt lgkmcnt(0)
  v_readfirstlane_b32 s92, v244
  s_mov_b64 exec, -1
  s_cmp_lg_u32 s92, 3
  s_cbranch_scc1 L_nf2_24
  s_mov_b64 exec, 1
  v_mov_b32 v244, s43
  v_mov_b32 v245, s43
  v_mov_b32 v246, s43
  v_mov_b32 v247, s43
  s_lshl_b32 s92, s41, 6
  s_add_u32 s92, s92, s42
  s_lshl_b32 s92, s92, 4
  s_add_u32 s92, s92, 131072
  buffer_store_dwordx4 v[244:247], v248, s[84:87], s92 offen sc1
  s_mov_b64 exec, -1
L_nf2_24:
  s_nop 1
  s_lshl_b32 s92, s44, 8
  s_mul_i32 s93, s40, 10240
  s_add_u32 s92, s92, s93
  v_lshlrev_b32 v243, 4, v1
  buffer_load_dwordx4 v[244:247], v243, s[72:75], s92 offen sc1
  s_add_u32 s92, s92, 1024
  buffer_load_dwordx4 v[244:247], v243, s[72:75], s92 offen sc1
  s_add_u32 s92, s92, 1024
  buffer_load_dwordx4 v[244:247], v243, s[72:75], s92 offen sc1
  s_add_u32 s92, s92, 1024
  buffer_load_dwordx4 v[244:247], v243, s[72:75], s92 offen sc1
  s_add_u32 s92, s92, 1024
  buffer_load_dwordx4 v[244:247], v243, s[72:75], s92 offen sc1
  s_add_u32 s92, s92, 1024
  buffer_load_dwordx4 v[244:247], v243, s[72:75], s92 offen sc1
  s_add_u32 s92, s92, 1024
  buffer_load_dwordx4 v[244:247], v243, s[72:75], s92 offen sc1
  s_add_u32 s92, s92, 1024
  buffer_load_dwordx4 v[244:247], v243, s[72:75], s92 offen sc1
  s_add_u32 s92, s92, 1024
  buffer_load_dwordx4 v[244:247], v243, s[72:75], s92 offen sc1
  s_add_u32 s92, s92, 1024
  buffer_load_dwordx4 v[244:247], v243, s[72:75], s92 offen sc1
  s_add_u32 s92, s92, 1024
  s_waitcnt lgkmcnt(11)
  v_mfma_f32_16x16x32_bf16 v[224:227], v[192:195], v[64:67], 0
  v_mfma_f32_16x16x32_bf16 v[228:231], v[192:195], v[128:131], 0
  s_waitcnt lgkmcnt(10)
  v_mfma_f32_16x16x32_bf16 v[224:227], v[196:199], v[68:71], v[224:227]
  v_mfma_f32_16x16x32_bf16 v[228:231], v[196:199], v[132:135], v[228:231]
  s_waitcnt lgkmcnt(9)
  v_mfma_f32_16x16x32_bf16 v[224:227], v[200:203], v[72:75], v[224:227]
  v_mfma_f32_16x16x32_bf16 v[228:231], v[200:203], v[136:139], v[228:231]
  s_waitcnt lgkmcnt(8)
  v_mfma_f32_16x16x32_bf16 v[224:227], v[204:207], v[76:79], v[224:227]
  v_mul_f32 v232, 0xbfb8aa3b, v232
  v_mul_f32 v233, 0xbfb8aa3b, v233
  v_mfma_f32_16x16x32_bf16 v[228:231], v[204:207], v[140:143], v[228:231]
  v_mul_f32 v234, 0xbfb8aa3b, v234
  s_waitcnt lgkmcnt(7)
  v_mfma_f32_16x16x32_bf16 v[224:227], v[208:211], v[80:83], v[224:227]
  v_mul_f32 v235, 0xbfb8aa3b, v235
  v_cvt_pk_bf16_f32 v232, v232, v236
  v_mfma_f32_16x16x32_bf16 v[228:231], v[208:211], v[144:147], v[228:231]
  v_cvt_pk_bf16_f32 v233, v233, v237
  s_waitcnt lgkmcnt(6)
  v_mfma_f32_16x16x32_bf16 v[224:227], v[212:215], v[84:87], v[224:227]
  v_cvt_pk_bf16_f32 v234, v234, v238
  v_cvt_pk_bf16_f32 v235, v235, v239
  v_mfma_f32_16x16x32_bf16 v[228:231], v[212:215], v[148:151], v[228:231]
  ds_write_b32 v242, v232 offset:8256
  s_waitcnt lgkmcnt(5)
  v_mfma_f32_16x16x32_bf16 v[224:227], v[216:219], v[88:91], v[224:227]
  ds_write_b32 v242, v233 offset:8512
  v_mfma_f32_16x16x32_bf16 v[228:231], v[216:219], v[152:155], v[228:231]
  ds_write_b32 v242, v234 offset:8768
  s_waitcnt lgkmcnt(4)
  v_mfma_f32_16x16x32_bf16 v[224:227], v[220:223], v[92:95], v[224:227]
  ds_write_b32 v242, v235 offset:9024
  v_mfma_f32_16x16x32_bf16 v[228:231], v[220:223], v[156:159], v[228:231]
  v_mfma_f32_16x16x32_bf16 v[232:235], v[192:195], v[96:99], 0
  v_mfma_f32_16x16x32_bf16 v[236:239], v[192:195], v[160:163], 0
  ds_read_b128 v[192:195], v60 offset:0
  v_mfma_f32_16x16x32_bf16 v[232:235], v[196:199], v[100:103], v[232:235]
  v_mfma_f32_16x16x32_bf16 v[236:239], v[196:199], v[164:167], v[236:239]
  ds_read_b128 v[196:199], v61 offset:0
  v_mfma_f32_16x16x32_bf16 v[232:235], v[200:203], v[104:107], v[232:235]
  v_mfma_f32_16x16x32_bf16 v[236:239], v[200:203], v[168:171], v[236:239]
  ds_read_b128 v[200:203], v62 offset:0
  v_mfma_f32_16x16x32_bf16 v[232:235], v[204:207], v[108:111], v[232:235]
  v_mfma_f32_16x16x32_bf16 v[236:239], v[204:207], v[172:175], v[236:239]
  ds_read_b128 v[204:207], v63 offset:0
  v_mul_f32 v224, 0xbfb8aa3b, v224
  v_mul_f32 v225, 0xbfb8aa3b, v225
  v_mul_f32 v226, 0xbfb8aa3b, v226
  v_mfma_f32_16x16x32_bf16 v[232:235], v[208:211], v[112:115], v[232:235]
  v_mfma_f32_16x16x32_bf16 v[236:239], v[208:211], v[176:179], v[236:239]
  ds_read_b128 v[208:211], v60 offset:256
  v_mul_f32 v227, 0xbfb8aa3b, v227
  v_cvt_pk_bf16_f32 v224, v224, v228
  v_cvt_pk_bf16_f32 v225, v225, v229
  v_mfma_f32_16x16x32_bf16 v[232:235], v[212:215], v[116:119], v[232:235]
  v_mfma_f32_16x16x32_bf16 v[236:239], v[212:215], v[180:183], v[236:239]
  ds_read_b128 v[212:215], v61 offset:256
  v_cvt_pk_bf16_f32 v226, v226, v230
  v_cvt_pk_bf16_f32 v227, v227, v231
  ds_write_b32 v242, v224 offset:12288
  v_mfma_f32_16x16x32_bf16 v[232:235], v[216:219], v[120:123], v[232:235]
  v_mfma_f32_16x16x32_bf16 v[236:239], v[216:219], v[184:187], v[236:239]
  ds_read_b128 v[216:219], v62 offset:256
  ds_write_b32 v242, v225 offset:12544
  ds_write_b32 v242, v226 offset:12800
  v_mfma_f32_16x16x32_bf16 v[232:235], v[220:223], v[124:127], v[232:235]
  v_mfma_f32_16x16x32_bf16 v[236:239], v[220:223], v[188:191], v[236:239]
  ds_read_b128 v[220:223], v63 offset:256
  ds_write_b32 v242, v227 offset:13056
  s_waitcnt lgkmcnt(11)
  v_mfma_f32_16x16x32_bf16 v[224:227], v[192:195], v[64:67], 0
  v_mfma_f32_16x16x32_bf16 v[228:231], v[192:195], v[128:131], 0
  s_waitcnt lgkmcnt(10)
  v_mfma_f32_16x16x32_bf16 v[224:227], v[196:199], v[68:71], v[224:227]
  v_mfma_f32_16x16x32_bf16 v[228:231], v[196:199], v[132:135], v[228:231]
  s_waitcnt lgkmcnt(9)
  v_mfma_f32_16x16x32_bf16 v[224:227], v[200:203], v[72:75], v[224:227]
  v_mfma_f32_16x16x32_bf16 v[228:231], v[200:203], v[136:139], v[228:231]
  s_waitcnt lgkmcnt(8)
  v_mfma_f32_16x16x32_bf16 v[224:227], v[204:207], v[76:79], v[224:227]
  v_mul_f32 v232, 0xbfb8aa3b, v232
  v_mul_f32 v233, 0xbfb8aa3b, v233
  v_mfma_f32_16x16x32_bf16 v[228:231], v[204:207], v[140:143], v[228:231]
  v_mul_f32 v234, 0xbfb8aa3b, v234
  s_waitcnt lgkmcnt(7)
  v_mfma_f32_16x16x32_bf16 v[224:227], v[208:211], v[80:83], v[224:227]
  v_mul_f32 v235, 0xbfb8aa3b, v235
  v_cvt_pk_bf16_f32 v232, v232, v236
  v_mfma_f32_16x16x32_bf16 v[228:231], v[208:211], v[144:147], v[228:231]
  v_cvt_pk_bf16_f32 v233, v233, v237
  s_waitcnt lgkmcnt(6)
  v_mfma_f32_16x16x32_bf16 v[224:227], v[212:215], v[84:87], v[224:227]
  v_cvt_pk_bf16_f32 v234, v234, v238
  v_cvt_pk_bf16_f32 v235, v235, v239
  v_mfma_f32_16x16x32_bf16 v[228:231], v[212:215], v[148:151], v[228:231]
  ds_write_b32 v242, v232 offset:12352
  s_waitcnt lgkmcnt(5)
  v_mfma_f32_16x16x32_bf16 v[224:227], v[216:219], v[88:91], v[224:227]
  ds_write_b32 v242, v233 offset:12608
  v_mfma_f32_16x16x32_bf16 v[228:231], v[216:219], v[152:155], v[228:231]
  ds_write_b32 v242, v234 offset:12864
  s_waitcnt lgkmcnt(4)
  v_mfma_f32_16x16x32_bf16 v[224:227], v[220:223], v[92:95], v[224:227]
  ds_write_b32 v242, v235 offset:13120
  v_mfma_f32_16x16x32_bf16 v[228:231], v[220:223], v[156:159], v[228:231]
  v_mfma_f32_16x16x32_bf16 v[232:235], v[192:195], v[96:99], 0
  v_mfma_f32_16x16x32_bf16 v[236:239], v[192:195], v[160:163], 0
  v_mfma_f32_16x16x32_bf16 v[232:235], v[196:199], v[100:103], v[232:235]
  v_mfma_f32_16x16x32_bf16 v[236:239], v[196:199], v[164:167], v[236:239]
  v_mfma_f32_16x16x32_bf16 v[232:235], v[200:203], v[104:107], v[232:235]
  v_mfma_f32_16x16x32_bf16 v[236:239], v[200:203], v[168:171], v[236:239]
  v_mfma_f32_16x16x32_bf16 v[232:235], v[204:207], v[108:111], v[232:235]
  v_mfma_f32_16x16x32_bf16 v[236:239], v[204:207], v[172:175], v[236:239]
  v_mul_f32 v224, 0xbfb8aa3b, v224
  v_mul_f32 v225, 0xbfb8aa3b, v225
  v_mul_f32 v226, 0xbfb8aa3b, v226
  v_mfma_f32_16x16x32_bf16 v[232:235], v[208:211], v[112:115], v[232:235]
  v_mfma_f32_16x16x32_bf16 v[236:239], v[208:211], v[176:179], v[236:239]
  v_mul_f32 v227, 0xbfb8aa3b, v227
  v_cvt_pk_bf16_f32 v224, v224, v228
  v_cvt_pk_bf16_f32 v225, v225, v229
  v_mfma_f32_16x16x32_bf16 v[232:235], v[212:215], v[116:119], v[232:235]
  v_mfma_f32_16x16x32_bf16 v[236:239], v[212:215], v[180:183], v[236:239]
  v_cvt_pk_bf16_f32 v226, v226, v230
  v_cvt_pk_bf16_f32 v227, v227, v231
  ds_write_b32 v242, v224 offset:16384
  v_mfma_f32_16x16x32_bf16 v[232:235], v[216:219], v[120:123], v[232:235]
  v_mfma_f32_16x16x32_bf16 v[236:239], v[216:219], v[184:187], v[236:239]
  ds_write_b32 v242, v225 offset:16640
  ds_write_b32 v242, v226 offset:16896
  v_mfma_f32_16x16x32_bf16 v[232:235], v[220:223], v[124:127], v[232:235]
  v_mfma_f32_16x16x32_bf16 v[236:239], v[220:223], v[188:191], v[236:239]
  ds_write_b32 v242, v227 offset:17152
  s_nop 7
  v_mul_f32 v232, 0xbfb8aa3b, v232
  v_mul_f32 v233, 0xbfb8aa3b, v233
  v_mul_f32 v234, 0xbfb8aa3b, v234
  v_mul_f32 v235, 0xbfb8aa3b, v235
  v_cvt_pk_bf16_f32 v232, v232, v236
  v_cvt_pk_bf16_f32 v233, v233, v237
  v_cvt_pk_bf16_f32 v234, v234, v238
  v_cvt_pk_bf16_f32 v235, v235, v239
  ds_write_b32 v242, v232 offset:16448
  ds_write_b32 v242, v233 offset:16704
  ds_write_b32 v242, v234 offset:16960
  ds_write_b32 v242, v235 offset:17216
  s_waitcnt lgkmcnt(0)
  s_branch L_main_setup
L_eteam_b:
  s_sub_u32 s94, s40, 4
  v_lshrrev_b32 v17, 3, v1
  s_lshl_b32 s92, s94, 3
  v_add_u32 v17, s92, v17
  v_lshlrev_b32 v176, 3, v17
  v_and_b32 v18, 7, v1
  v_mul_u32_u24 v177, 5632, v17
  v_lshl_add_u32 v177, v18, 4, v177
  v_lshlrev_b32 v178, 1, v18
  v_add_u32 v179, 1, v178
  v_add_u32 v180, 16, v178
  v_add_u32 v181, 17, v178
  s_mov_b32 s96, 0
L_spin_25:
  ds_read_b32 v17, v248 offset:3840
  s_waitcnt lgkmcnt(0)
  v_readfirstlane_b32 s92, v17
  s_add_u32 s96, s96, 1
  s_cmp_ge_u32 s92, 4
  s_cbranch_scc1 L_spind_26
  s_sleep 1
  s_cmp_lt_u32 s96, 0x40000
  s_cbranch_scc1 L_spin_25
L_spind_26:
  s_sub_u32 s94, s40, 4
  s_lshl_b32 s94, s94, 10
  s_add_u32 m0, s94, 86016
  s_mov_b32 s93, 0
  buffer_load_dwordx4 v249, s[64:67], s93 offen lds
  s_add_u32 m0, s94, 118784
  s_nop 0
  buffer_load_dwordx4 v249, s[68:71], s93 offen lds
  s_waitcnt vmcnt(8)
  s_add_u32 m0, s94, 90112
  s_mov_b32 s93, 16384
  buffer_load_dwordx4 v249, s[64:67], s93 offen lds
  s_add_u32 m0, s94, 122880
  s_nop 0
  buffer_load_dwordx4 v249, s[68:71], s93 offen lds
  s_waitcnt vmcnt(8)
  s_add_u32 m0, s94, 94208
  s_mov_b32 s93, 32768
  buffer_load_dwordx4 v249, s[64:67], s93 offen lds
  s_add_u32 m0, s94, 126976
  s_nop 0
  buffer_load_dwordx4 v249, s[68:71], s93 offen lds
  s_waitcnt vmcnt(8)
  s_add_u32 m0, s94, 98304
  s_mov_b32 s93, 49152
  buffer_load_dwordx4 v249, s[64:67], s93 offen lds
  s_add_u32 m0, s94, 131072
  s_nop 0
  buffer_load_dwordx4 v249, s[68:71], s93 offen lds
  s_waitcnt vmcnt(8)
  s_add_u32 m0, s94, 102400
  s_mov_b32 s93, 65536
  buffer_load_dwordx4 v249, s[64:67], s93 offen lds
  s_add_u32 m0, s94, 135168
  s_nop 0
  buffer_load_dwordx4 v249, s[68:71], s93 offen lds
  s_waitcnt vmcnt(8)
  s_add_u32 m0, s94, 106496
  s_mov_b32 s93, 81920
  buffer_load_dwordx4 v249, s[64:67], s93 offen lds
  s_add_u32 m0, s94, 139264
  s_nop 0
  buffer_load_dwordx4 v249, s[68:71], s93 offen lds
  s_waitcnt vmcnt(8)
  s_add_u32 m0, s94, 110592
  s_mov_b32 s93, 98304
  buffer_load_dwordx4 v249, s[64:67], s93 offen lds
  s_add_u32 m0, s94, 143360
  s_nop 0
  buffer_load_dwordx4 v249, s[68:71], s93 offen lds
  s_waitcnt vmcnt(8)
  s_add_u32 m0, s94, 114688
  s_mov_b32 s93, 114688
  buffer_load_dwordx4 v249, s[64:67], s93 offen lds
  s_add_u32 m0, s94, 147456
  s_nop 0
  buffer_load_dwordx4 v249, s[68:71], s93 offen lds
  s_waitcnt vmcnt(8)
  s_add_u32 m0, s94, 20480
  s_lshl_b32 s93, s44, 9
  s_add_u32 s93, s93, 16384
  buffer_load_dwordx4 v246, s[48:51], s93 offen lds
  s_add_u32 m0, s94, 24576
  s_nop 0
  buffer_load_dwordx4 v247, s[48:51], s93 offen lds
  s_waitcnt vmcnt(8)
  s_add_u32 m0, s94, 61440
  s_lshl_b32 s93, s44, 9
  s_add_u32 s93, s93, 57344
  buffer_load_dwordx4 v246, s[48:51], s93 offen lds
  s_add_u32 m0, s94, 65536
  s_nop 0
  buffer_load_dwordx4 v247, s[48:51], s93 offen lds
  s_waitcnt vmcnt(8)
  s_add_u32 m0, s94, 28672
  s_lshl_b32 s93, s44, 9
  s_add_u32 s93, s93, 24576
  buffer_load_dwordx4 v246, s[48:51], s93 offen lds
  s_add_u32 m0, s94, 32768
  s_nop 0
  buffer_load_dwordx4 v247, s[48:51], s93 offen lds
  s_waitcnt vmcnt(8)
  s_add_u32 m0, s94, 69632
  s_lshl_b32 s93, s44, 9
  s_add_u32 s93, s93, 65536
  buffer_load_dwordx4 v246, s[48:51], s93 offen lds
  s_add_u32 m0, s94, 73728
  s_nop 0
  buffer_load_dwordx4 v247, s[48:51], s93 offen lds
  s_waitcnt vmcnt(8)
  v_mov_b32 v17, 1
  s_mov_b64 exec, 1
  ds_add_u32 v248, v17 offset:3920
  s_mov_b64 exec, -1
  s_add_u32 m0, s94, 36864
  s_lshl_b32 s93, s44, 9
  s_add_u32 s93, s93, 32768
  buffer_load_dwordx4 v246, s[48:51], s93 offen lds
  s_add_u32 m0, s94, 40960
  s_nop 0
  buffer_load_dwordx4 v247, s[48:51], s93 offen lds
  s_waitcnt vmcnt(8)
  s_add_u32 m0, s94, 77824
  s_lshl_b32 s93, s44, 9
  s_add_u32 s93, s93, 73728
  buffer_load_dwordx4 v246, s[48:51], s93 offen lds
  s_add_u32 m0, s94, 81920
  s_nop 0
  buffer_load_dwordx4 v247, s[48:51], s93 offen lds
  s_waitcnt vmcnt(8)
  v_mov_b32 v17, 1
  s_mov_b64 exec, 1
  ds_add_u32 v248, v17 offset:3908
  s_mov_b64 exec, -1
  s_lshl_b32 s95, s42, 11
  s_mov_b32 s96, 0
L_poll1_27:
  buffer_load_dwordx2 v[64:65], v176, s[84:87], s95 offen offset:0 sc1
  buffer_load_dwordx2 v[66:67], v176, s[84:87], s95 offen offset:256 sc1
  buffer_load_dwordx2 v[68:69], v176, s[84:87], s95 offen offset:512 sc1
  buffer_load_dwordx2 v[70:71], v176, s[84:87], s95 offen offset:768 sc1
  buffer_load_dwordx2 v[72:73], v176, s[84:87], s95 offen offset:1024 sc1
  buffer_load_dwordx2 v[74:75], v176, s[84:87], s95 offen offset:1280 sc1
  buffer_load_dwordx2 v[76:77], v176, s[84:87], s95 offen offset:1536 sc1
  buffer_load_dwordx2 v[78:79], v176, s[84:87], s95 offen offset:1792 sc1
  v_mov_b32 v19, s43
  s_cmp_lg_u32 s96, 0
  s_cbranch_scc1 L_xl_29
  s_waitcnt vmcnt(12)
  v_mov_b32 v17, 1
  s_mov_b64 exec, 1
  ds_add_u32 v248, v17 offset:3912
  s_mov_b64 exec, -1
  s_waitcnt vmcnt(8)
  v_mov_b32 v17, 1
  s_mov_b64 exec, 1
  ds_add_u32 v248, v17 offset:3916
  s_mov_b64 exec, -1
L_xl_29:
  s_waitcnt vmcnt(0)
  v_xor_b32 v20, v65, v19
  v_xor_b32 v21, v67, v19
  v_or_b32 v20, v20, v21
  v_xor_b32 v21, v69, v19
  v_or_b32 v20, v20, v21
  v_xor_b32 v21, v71, v19
  v_or_b32 v20, v20, v21
  v_xor_b32 v21, v73, v19
  v_or_b32 v20, v20, v21
  v_xor_b32 v21, v75, v19
  v_or_b32 v20, v20, v21
  v_xor_b32 v21, v77, v19
  v_or_b32 v20, v20, v21
  v_xor_b32 v21, v79, v19
  v_or_b32 v20, v20, v21
  v_cmp_ne_u32 vcc, 0, v20
  s_cbranch_vccz L_poll1d_28
  s_sleep 6
  s_add_u32 s96, s96, 1
  s_cmp_lt_u32 s96, 0x10000
  s_cbranch_scc1 L_poll1_27
L_poll1d_28:
  v_mov_b32 v20, 0
  v_lshrrev_b32 v65, 16, v64
  v_max_u32 v20, v20, v65
  v_lshrrev_b32 v67, 16, v66
  v_max_u32 v20, v20, v67
  v_lshrrev_b32 v69, 16, v68
  v_max_u32 v20, v20, v69
  v_lshrrev_b32 v71, 16, v70
  v_max_u32 v20, v20, v71
  v_lshrrev_b32 v73, 16, v72
  v_max_u32 v20, v20, v73
  v_lshrrev_b32 v75, 16, v74
  v_max_u32 v20, v20, v75
  v_lshrrev_b32 v77, 16, v76
  v_max_u32 v20, v20, v77
  v_lshrrev_b32 v79, 16, v78
  v_max_u32 v20, v20, v79
  v_cmp_lt_u32 vcc, 32, v20
  s_cbranch_vccz L_nofb_30
  v_mov_b32 v21, 1
  ds_write_b32 v248, v21 offset:3864
L_nofb_30:
  s_mov_b32 s96, 0
L_recld_31:
  v_and_b32 v19, 0xffff, v64
  v_lshl_add_u32 v19, v19, 3, v177
  s_mov_b32 s92, 0
  v_cmp_lt_u32 vcc, 16, v65
  buffer_load_dwordx4 v[80:83], v19, s[80:83], s92 offen sc1
  s_cbranch_vccz L_ld1_33
  buffer_load_dwordx4 v[112:115], v19, s[80:83], s92 offen offset:128 sc1
L_ld1_33:
  v_and_b32 v19, 0xffff, v66
  v_lshl_add_u32 v19, v19, 3, v177
  s_mov_b32 s92, 180224
  v_cmp_lt_u32 vcc, 16, v67
  buffer_load_dwordx4 v[84:87], v19, s[80:83], s92 offen sc1
  s_cbranch_vccz L_ld1_34
  buffer_load_dwordx4 v[116:119], v19, s[80:83], s92 offen offset:128 sc1
L_ld1_34:
  v_and_b32 v19, 0xffff, v68
  v_lshl_add_u32 v19, v19, 3, v177
  s_mov_b32 s92, 360448
  v_cmp_lt_u32 vcc, 16, v69
  buffer_load_dwordx4 v[88:91], v19, s[80:83], s92 offen sc1
  s_cbranch_vccz L_ld1_35
  buffer_load_dwordx4 v[120:123], v19, s[80:83], s92 offen offset:128 sc1
L_ld1_35:
  v_and_b32 v19, 0xffff, v70
  v_lshl_add_u32 v19, v19, 3, v177
  s_mov_b32 s92, 540672
  v_cmp_lt_u32 vcc, 16, v71
  buffer_load_dwordx4 v[92:95], v19, s[80:83], s92 offen sc1
  s_cbranch_vccz L_ld1_36
  buffer_load_dwordx4 v[124:127], v19, s[80:83], s92 offen offset:128 sc1
L_ld1_36:
  v_and_b32 v19, 0xffff, v72
  v_lshl_add_u32 v19, v19, 3, v177
  s_mov_b32 s92, 720896
  v_cmp_lt_u32 vcc, 16, v73
  buffer_load_dwordx4 v[96:99], v19, s[80:83], s92 offen sc1
  s_cbranch_vccz L_ld1_37
  buffer_load_dwordx4 v[128:131], v19, s[80:83], s92 offen offset:128 sc1
L_ld1_37:
  v_and_b32 v19, 0xffff, v74
  v_lshl_add_u32 v19, v19, 3, v177
  s_mov_b32 s92, 901120
  v_cmp_lt_u32 vcc, 16, v75
  buffer_load_dwordx4 v[100:103], v19, s[80:83], s92 offen sc1
  s_cbranch_vccz L_ld1_38
  buffer_load_dwordx4 v[132:135], v19, s[80:83], s92 offen offset:128 sc1
L_ld1_38:
  v_and_b32 v19, 0xffff, v76
  v_lshl_add_u32 v19, v19, 3, v177
  s_mov_b32 s92, 1081344
  v_cmp_lt_u32 vcc, 16, v77
  buffer_load_dwordx4 v[104:107], v19, s[80:83], s92 offen sc1
  s_cbranch_vccz L_ld1_39
  buffer_load_dwordx4 v[136:139], v19, s[80:83], s92 offen offset:128 sc1
L_ld1_39:
  v_and_b32 v19, 0xffff, v78
  v_lshl_add_u32 v19, v19, 3, v177
  s_mov_b32 s92, 1261568
  v_cmp_lt_u32 vcc, 16, v79
  buffer_load_dwordx4 v[108:111], v19, s[80:83], s92 offen sc1
  s_cbranch_vccz L_ld1_40
  buffer_load_dwordx4 v[140:143], v19, s[80:83], s92 offen offset:128 sc1
L_ld1_40:
  s_cmp_lg_u32 s96, 0
  s_cbranch_scc1 L_sig_41_r
  v_mov_b32 v20, 1
  s_mov_b64 exec, 1
  ds_add_u32 v248, v20 offset:3892
  s_mov_b64 exec, -1
  s_waitcnt vmcnt(0)
  s_branch L_sig_41
L_sig_41_r:
  s_waitcnt vmcnt(0)
L_sig_41:
  v_mov_b32 v21, 0x05040100
  v_mov_b32 v22, 0
  v_mov_b32 v23, s43
  v_cmpx_lt_u32 vcc, v178, v65
  v_perm_b32 v20, v83, v81, v21
  v_xor_b32 v20, v20, v23
  v_or_b32 v22, v22, v20
  s_mov_b64 exec, -1
  v_cmp_lt_u32 vcc, 16, v65
  s_cbranch_vccz L_v1_42
  v_cmpx_lt_u32 vcc, v180, v65
  v_perm_b32 v20, v115, v113, v21
  v_xor_b32 v20, v20, v23
  v_or_b32 v22, v22, v20
  s_mov_b64 exec, -1
L_v1_42:
  v_cmpx_lt_u32 vcc, v178, v67
  v_perm_b32 v20, v87, v85, v21
  v_xor_b32 v20, v20, v23
  v_or_b32 v22, v22, v20
  s_mov_b64 exec, -1
  v_cmp_lt_u32 vcc, 16, v67
  s_cbranch_vccz L_v1_43
  v_cmpx_lt_u32 vcc, v180, v67
  v_perm_b32 v20, v119, v117, v21
  v_xor_b32 v20, v20, v23
  v_or_b32 v22, v22, v20
  s_mov_b64 exec, -1
L_v1_43:
  v_cmpx_lt_u32 vcc, v178, v69
  v_perm_b32 v20, v91, v89, v21
  v_xor_b32 v20, v20, v23
  v_or_b32 v22, v22, v20
  s_mov_b64 exec, -1
  v_cmp_lt_u32 vcc, 16, v69
  s_cbranch_vccz L_v1_44
  v_cmpx_lt_u32 vcc, v180, v69
  v_perm_b32 v20, v123, v121, v21
  v_xor_b32 v20, v20, v23
  v_or_b32 v22, v22, v20
  s_mov_b64 exec, -1
L_v1_44:
  v_cmpx_lt_u32 vcc, v178, v71
  v_perm_b32 v20, v95, v93, v21
  v_xor_b32 v20, v20, v23
  v_or_b32 v22, v22, v20
  s_mov_b64 exec, -1
  v_cmp_lt_u32 vcc, 16, v71
  s_cbranch_vccz L_v1_45
  v_cmpx_lt_u32 vcc, v180, v71
  v_perm_b32 v20, v127, v125, v21
  v_xor_b32 v20, v20, v23
  v_or_b32 v22, v22, v20
  s_mov_b64 exec, -1
L_v1_45:
  v_cmpx_lt_u32 vcc, v178, v73
  v_perm_b32 v20, v99, v97, v21
  v_xor_b32 v20, v20, v23
  v_or_b32 v22, v22, v20
  s_mov_b64 exec, -1
  v_cmp_lt_u32 vcc, 16, v73
  s_cbranch_vccz L_v1_46
  v_cmpx_lt_u32 vcc, v180, v73
  v_perm_b32 v20, v131, v129, v21
  v_xor_b32 v20, v20, v23
  v_or_b32 v22, v22, v20
  s_mov_b64 exec, -1
L_v1_46:
  v_cmpx_lt_u32 vcc, v178, v75
  v_perm_b32 v20, v103, v101, v21
  v_xor_b32 v20, v20, v23
  v_or_b32 v22, v22, v20
  s_mov_b64 exec, -1
  v_cmp_lt_u32 vcc, 16, v75
  s_cbranch_vccz L_v1_47
  v_cmpx_lt_u32 vcc, v180, v75
  v_perm_b32 v20, v135, v133, v21
  v_xor_b32 v20, v20, v23
  v_or_b32 v22, v22, v20
  s_mov_b64 exec, -1
L_v1_47:
  v_cmpx_lt_u32 vcc, v178, v77
  v_perm_b32 v20, v107, v105, v21
  v_xor_b32 v20, v20, v23
  v_or_b32 v22, v22, v20
  s_mov_b64 exec, -1
  v_cmp_lt_u32 vcc, 16, v77
  s_cbranch_vccz L_v1_48
  v_cmpx_lt_u32 vcc, v180, v77
  v_perm_b32 v20, v139, v137, v21
  v_xor_b32 v20, v20, v23
  v_or_b32 v22, v22, v20
  s_mov_b64 exec, -1
L_v1_48:
  v_cmpx_lt_u32 vcc, v178, v79
  v_perm_b32 v20, v111, v109, v21
  v_xor_b32 v20, v20, v23
  v_or_b32 v22, v22, v20
  s_mov_b64 exec, -1
  v_cmp_lt_u32 vcc, 16, v79
  s_cbranch_vccz L_v1_49
  v_cmpx_lt_u32 vcc, v180, v79
  v_perm_b32 v20, v143, v141, v21
  v_xor_b32 v20, v20, v23
  v_or_b32 v22, v22, v20
  s_mov_b64 exec, -1
L_v1_49:
  v_cmp_ne_u32 vcc, 0, v22
  s_cbranch_vccz L_recok_32
  s_sleep 2
  s_add_u32 s96, s96, 1
  s_cmp_lt_u32 s96, 0x10000
  s_cbranch_scc1 L_recld_31
L_recok_32:
  v_mov_b32 v22, 1
  v_mov_b32 v23, 64
  v_cmpx_lt_u32 vcc, v178, v65
  v_lshlrev_b32_sdwa v20, 2, v80 dst_sel:DWORD dst_unused:UNUSED_PAD src0_sel:DWORD src1_sel:BYTE_0
  ds_add_rtn_u32 v200, v20, v22 offset:256
  v_cmpx_lt_u32 vcc, v179, v65
  v_lshlrev_b32_sdwa v20, 2, v82 dst_sel:DWORD dst_unused:UNUSED_PAD src0_sel:DWORD src1_sel:BYTE_0
  ds_add_rtn_u32 v201, v20, v22 offset:256
  s_mov_b64 exec, -1
  v_cmp_lt_u32 vcc, 16, v65
  s_cbranch_vccz L_st1_50
  v_cmpx_lt_u32 vcc, v180, v65
  v_lshlrev_b32_sdwa v20, 2, v112 dst_sel:DWORD dst_unused:UNUSED_PAD src0_sel:DWORD src1_sel:BYTE_0
  ds_add_rtn_u32 v202, v20, v22 offset:256
  v_cmpx_lt_u32 vcc, v181, v65
  v_lshlrev_b32_sdwa v20, 2, v114 dst_sel:DWORD dst_unused:UNUSED_PAD src0_sel:DWORD src1_sel:BYTE_0
  ds_add_rtn_u32 v203, v20, v22 offset:256
  s_mov_b64 exec, -1
L_st1_50:
  v_cmpx_lt_u32 vcc, v178, v67
  v_lshlrev_b32_sdwa v20, 2, v84 dst_sel:DWORD dst_unused:UNUSED_PAD src0_sel:DWORD src1_sel:BYTE_0
  ds_add_rtn_u32 v204, v20, v22 offset:256
  v_cmpx_lt_u32 vcc, v179, v67
  v_lshlrev_b32_sdwa v20, 2, v86 dst_sel:DWORD dst_unused:UNUSED_PAD src0_sel:DWORD src1_sel:BYTE_0
  ds_add_rtn_u32 v205, v20, v22 offset:256
  s_mov_b64 exec, -1
  v_cmp_lt_u32 vcc, 16, v67
  s_cbranch_vccz L_st1_51
  v_cmpx_lt_u32 vcc, v180, v67
  v_lshlrev_b32_sdwa v20, 2, v116 dst_sel:DWORD dst_unused:UNUSED_PAD src0_sel:DWORD src1_sel:BYTE_0
  ds_add_rtn_u32 v206, v20, v22 offset:256
  v_cmpx_lt_u32 vcc, v181, v67
  v_lshlrev_b32_sdwa v20, 2, v118 dst_sel:DWORD dst_unused:UNUSED_PAD src0_sel:DWORD src1_sel:BYTE_0
  ds_add_rtn_u32 v207, v20, v22 offset:256
  s_mov_b64 exec, -1
L_st1_51:
  v_cmpx_lt_u32 vcc, v178, v69
  v_lshlrev_b32_sdwa v20, 2, v88 dst_sel:DWORD dst_unused:UNUSED_PAD src0_sel:DWORD src1_sel:BYTE_0
  ds_add_rtn_u32 v208, v20, v22 offset:256
  v_cmpx_lt_u32 vcc, v179, v69
  v_lshlrev_b32_sdwa v20, 2, v90 dst_sel:DWORD dst_unused:UNUSED_PAD src0_sel:DWORD src1_sel:BYTE_0
  ds_add_rtn_u32 v209, v20, v22 offset:256
  s_mov_b64 exec, -1
  v_cmp_lt_u32 vcc, 16, v69
  s_cbranch_vccz L_st1_52
  v_cmpx_lt_u32 vcc, v180, v69
  v_lshlrev_b32_sdwa v20, 2, v120 dst_sel:DWORD dst_unused:UNUSED_PAD src0_sel:DWORD src1_sel:BYTE_0
  ds_add_rtn_u32 v210, v20, v22 offset:256
  v_cmpx_lt_u32 vcc, v181, v69
  v_lshlrev_b32_sdwa v20, 2, v122 dst_sel:DWORD dst_unused:UNUSED_PAD src0_sel:DWORD src1_sel:BYTE_0
  ds_add_rtn_u32 v211, v20, v22 offset:256
  s_mov_b64 exec, -1
L_st1_52:
  v_cmpx_lt_u32 vcc, v178, v71
  v_lshlrev_b32_sdwa v20, 2, v92 dst_sel:DWORD dst_unused:UNUSED_PAD src0_sel:DWORD src1_sel:BYTE_0
  ds_add_rtn_u32 v212, v20, v22 offset:256
  v_cmpx_lt_u32 vcc, v179, v71
  v_lshlrev_b32_sdwa v20, 2, v94 dst_sel:DWORD dst_unused:UNUSED_PAD src0_sel:DWORD src1_sel:BYTE_0
  ds_add_rtn_u32 v213, v20, v22 offset:256
  s_mov_b64 exec, -1
  v_cmp_lt_u32 vcc, 16, v71
  s_cbranch_vccz L_st1_53
  v_cmpx_lt_u32 vcc, v180, v71
  v_lshlrev_b32_sdwa v20, 2, v124 dst_sel:DWORD dst_unused:UNUSED_PAD src0_sel:DWORD src1_sel:BYTE_0
  ds_add_rtn_u32 v214, v20, v22 offset:256
  v_cmpx_lt_u32 vcc, v181, v71
  v_lshlrev_b32_sdwa v20, 2, v126 dst_sel:DWORD dst_unused:UNUSED_PAD src0_sel:DWORD src1_sel:BYTE_0
  ds_add_rtn_u32 v215, v20, v22 offset:256
  s_mov_b64 exec, -1
L_st1_53:
  v_cmpx_lt_u32 vcc, v178, v73
  v_lshlrev_b32_sdwa v20, 2, v96 dst_sel:DWORD dst_unused:UNUSED_PAD src0_sel:DWORD src1_sel:BYTE_0
  ds_add_rtn_u32 v216, v20, v22 offset:256
  v_cmpx_lt_u32 vcc, v179, v73
  v_lshlrev_b32_sdwa v20, 2, v98 dst_sel:DWORD dst_unused:UNUSED_PAD src0_sel:DWORD src1_sel:BYTE_0
  ds_add_rtn_u32 v217, v20, v22 offset:256
  s_mov_b64 exec, -1
  v_cmp_lt_u32 vcc, 16, v73
  s_cbranch_vccz L_st1_54
  v_cmpx_lt_u32 vcc, v180, v73
  v_lshlrev_b32_sdwa v20, 2, v128 dst_sel:DWORD dst_unused:UNUSED_PAD src0_sel:DWORD src1_sel:BYTE_0
  ds_add_rtn_u32 v218, v20, v22 offset:256
  v_cmpx_lt_u32 vcc, v181, v73
  v_lshlrev_b32_sdwa v20, 2, v130 dst_sel:DWORD dst_unused:UNUSED_PAD src0_sel:DWORD src1_sel:BYTE_0
  ds_add_rtn_u32 v219, v20, v22 offset:256
  s_mov_b64 exec, -1
L_st1_54:
  v_cmpx_lt_u32 vcc, v178, v75
  v_lshlrev_b32_sdwa v20, 2, v100 dst_sel:DWORD dst_unused:UNUSED_PAD src0_sel:DWORD src1_sel:BYTE_0
  ds_add_rtn_u32 v220, v20, v22 offset:256
  v_cmpx_lt_u32 vcc, v179, v75
  v_lshlrev_b32_sdwa v20, 2, v102 dst_sel:DWORD dst_unused:UNUSED_PAD src0_sel:DWORD src1_sel:BYTE_0
  ds_add_rtn_u32 v221, v20, v22 offset:256
  s_mov_b64 exec, -1
  v_cmp_lt_u32 vcc, 16, v75
  s_cbranch_vccz L_st1_55
  v_cmpx_lt_u32 vcc, v180, v75
  v_lshlrev_b32_sdwa v20, 2, v132 dst_sel:DWORD dst_unused:UNUSED_PAD src0_sel:DWORD src1_sel:BYTE_0
  ds_add_rtn_u32 v222, v20, v22 offset:256
  v_cmpx_lt_u32 vcc, v181, v75
  v_lshlrev_b32_sdwa v20, 2, v134 dst_sel:DWORD dst_unused:UNUSED_PAD src0_sel:DWORD src1_sel:BYTE_0
  ds_add_rtn_u32 v223, v20, v22 offset:256
  s_mov_b64 exec, -1
L_st1_55:
  v_cmpx_lt_u32 vcc, v178, v77
  v_lshlrev_b32_sdwa v20, 2, v104 dst_sel:DWORD dst_unused:UNUSED_PAD src0_sel:DWORD src1_sel:BYTE_0
  ds_add_rtn_u32 v224, v20, v22 offset:256
  v_cmpx_lt_u32 vcc, v179, v77
  v_lshlrev_b32_sdwa v20, 2, v106 dst_sel:DWORD dst_unused:UNUSED_PAD src0_sel:DWORD src1_sel:BYTE_0
  ds_add_rtn_u32 v225, v20, v22 offset:256
  s_mov_b64 exec, -1
  v_cmp_lt_u32 vcc, 16, v77
  s_cbranch_vccz L_st1_56
  v_cmpx_lt_u32 vcc, v180, v77
  v_lshlrev_b32_sdwa v20, 2, v136 dst_sel:DWORD dst_unused:UNUSED_PAD src0_sel:DWORD src1_sel:BYTE_0
  ds_add_rtn_u32 v226, v20, v22 offset:256
  v_cmpx_lt_u32 vcc, v181, v77
  v_lshlrev_b32_sdwa v20, 2, v138 dst_sel:DWORD dst_unused:UNUSED_PAD src0_sel:DWORD src1_sel:BYTE_0
  ds_add_rtn_u32 v227, v20, v22 offset:256
  s_mov_b64 exec, -1
L_st1_56:
  v_cmpx_lt_u32 vcc, v178, v79
  v_lshlrev_b32_sdwa v20, 2, v108 dst_sel:DWORD dst_unused:UNUSED_PAD src0_sel:DWORD src1_sel:BYTE_0
  ds_add_rtn_u32 v228, v20, v22 offset:256
  v_cmpx_lt_u32 vcc, v179, v79
  v_lshlrev_b32_sdwa v20, 2, v110 dst_sel:DWORD dst_unused:UNUSED_PAD src0_sel:DWORD src1_sel:BYTE_0
  ds_add_rtn_u32 v229, v20, v22 offset:256
  s_mov_b64 exec, -1
  v_cmp_lt_u32 vcc, 16, v79
  s_cbranch_vccz L_st1_57
  v_cmpx_lt_u32 vcc, v180, v79
  v_lshlrev_b32_sdwa v20, 2, v140 dst_sel:DWORD dst_unused:UNUSED_PAD src0_sel:DWORD src1_sel:BYTE_0
  ds_add_rtn_u32 v230, v20, v22 offset:256
  v_cmpx_lt_u32 vcc, v181, v79
  v_lshlrev_b32_sdwa v20, 2, v142 dst_sel:DWORD dst_unused:UNUSED_PAD src0_sel:DWORD src1_sel:BYTE_0
  ds_add_rtn_u32 v231, v20, v22 offset:256
  s_mov_b64 exec, -1
L_st1_57:
  v_mov_b32 v20, 1
  s_mov_b64 exec, 1
  ds_add_u32 v248, v20 offset:3852
  s_mov_b64 exec, -1
  s_cmp_lg_u32 s40, 4
  s_cbranch_scc1 L_e_prefill
  v_lshlrev_b32 v19, 2, v1
  v_mov_b32 v38, 31
  v_writelane_b32 v38, 0, 0
  v_writelane_b32 v38, 4, 1
  v_writelane_b32 v38, 11, 2
  v_writelane_b32 v38, 1, 3
  v_writelane_b32 v38, 5, 4
  v_writelane_b32 v38, 10, 5
  v_writelane_b32 v38, 2, 6
  v_writelane_b32 v38, 6, 7
  v_writelane_b32 v38, 9, 8
  v_writelane_b32 v38, 3, 9
  v_writelane_b32 v38, 7, 10
  v_writelane_b32 v38, 8, 11
  v_writelane_b32 v38, 15, 12
  v_writelane_b32 v38, 19, 13
  v_writelane_b32 v38, 14, 14
  v_writelane_b32 v38, 18, 15
  v_writelane_b32 v38, 13, 16
  v_writelane_b32 v38, 17, 17
  v_writelane_b32 v38, 12, 18
  v_writelane_b32 v38, 16, 19
  v_lshlrev_b32 v38, 2, v38
  v_sub_u32 v37, 252, v19
  s_mov_b32 s96, 0
L_spw_58:
  ds_read_b32 v20, v248 offset:3852
  ds_read_b32 v24, v19 offset:256
  ds_read_b32 v25, v19 offset:512
  ds_read_b32 v26, v19 offset:768
  s_waitcnt lgkmcnt(0)
  v_readfirstlane_b32 s92, v20
  s_add_u32 s96, s96, 1
  s_cmp_ge_u32 s92, 4
  s_cbranch_scc1 L_spwd_59
  s_cmp_lt_u32 s96, 0x40000
  s_cbranch_scc1 L_spw_58
L_spwd_59:
  v_min_u32 v28, 63, v24
  v_lshlrev_b32 v28, 2, v28
  ds_add_rtn_u32 v32, v28, v22 offset:1024
  v_min_u32 v29, 63, v25
  v_lshlrev_b32 v29, 2, v29
  ds_add_rtn_u32 v33, v29, v22 offset:1024
  v_min_u32 v30, 63, v26
  v_lshlrev_b32 v30, 2, v30
  v_cmpx_gt_u32 vcc, 32, v1
  ds_add_rtn_u32 v34, v30, v22 offset:1024
  s_mov_b64 exec, -1
  ds_read_b32 v36, v37 offset:1024
  v_sub_u32 v28, 252, v28
  v_sub_u32 v29, 252, v29
  v_sub_u32 v30, 252, v30
  s_waitcnt lgkmcnt(0)
  v_mov_b32 v39, v36
  s_nop 1
  v_add_u32_dpp v36, v36, v36 row_shr:1 row_mask:0xf bank_mask:0xf
  s_nop 1
  v_add_u32_dpp v36, v36, v36 row_shr:2 row_mask:0xf bank_mask:0xf
  s_nop 1
  v_add_u32_dpp v36, v36, v36 row_shr:4 row_mask:0xf bank_mask:0xf
  s_nop 1
  v_add_u32_dpp v36, v36, v36 row_shr:8 row_mask:0xf bank_mask:0xf
  s_nop 1
  v_add_u32_dpp v36, v36, v36 row_bcast:15 row_mask:0xa bank_mask:0xf
  s_nop 1
  v_add_u32_dpp v36, v36, v36 row_bcast:31 row_mask:0xc bank_mask:0xf
  s_nop 1
  v_sub_u32 v36, v36, v39
  ds_bpermute_b32 v28, v28, v36
  ds_bpermute_b32 v29, v29, v36
  ds_bpermute_b32 v30, v30, v36
  s_waitcnt lgkmcnt(0)
  v_add_u32 v32, v32, v28
  v_add_u32 v21, 0, v1
  v_cmp_gt_u32 vcc, s45, v21
  v_lshlrev_b32 v20, 3, v32
  v_lshrrev_b32 v28, 3, v32
  v_lshlrev_b32 v28, 2, v28
  v_mov_b32 v40, 0x200000
  v_and_b32 v43, 15, v21
  v_lshlrev_b32 v43, 4, v43
  v_lshl_add_u32 v43, v21, 9, v43
  v_cndmask_b32 v42, v40, v21, vcc
  ds_write_b64 v20, v[42:43] offset:2304
  ds_max_u32 v28, v24 offset:1280
  v_add_u32 v33, v33, v29
  v_add_u32 v21, 64, v1
  v_cmp_gt_u32 vcc, s45, v21
  v_lshlrev_b32 v20, 3, v33
  v_lshrrev_b32 v29, 3, v33
  v_lshlrev_b32 v29, 2, v29
  v_mov_b32 v40, 0x200000
  v_and_b32 v43, 15, v21
  v_lshlrev_b32 v43, 4, v43
  v_lshl_add_u32 v43, v21, 9, v43
  v_cndmask_b32 v42, v40, v21, vcc
  ds_write_b64 v20, v[42:43] offset:2304
  ds_max_u32 v29, v25 offset:1280
  v_add_u32 v34, v34, v30
  v_add_u32 v21, 128, v1
  v_cmp_gt_u32 vcc, s45, v21
  v_lshlrev_b32 v20, 3, v34
  v_lshrrev_b32 v30, 3, v34
  v_lshlrev_b32 v30, 2, v30
  v_mov_b32 v40, 0x200000
  v_and_b32 v43, 15, v21
  v_lshlrev_b32 v43, 4, v43
  v_lshl_add_u32 v43, v21, 9, v43
  v_cndmask_b32 v42, v40, v21, vcc
  v_cmpx_gt_u32 vcc, 32, v1
  ds_write_b64 v20, v[42:43] offset:2304
  ds_max_u32 v30, v26 offset:1280
  s_mov_b64 exec, -1
  ds_read_b32 v39, v38 offset:1280
  s_waitcnt lgkmcnt(0)
  v_add_u32 v39, 1, v39
  v_lshrrev_b32 v39, 1, v39
  v_mov_b32 v40, v39
  s_nop 1
  v_add_u32_dpp v39, v39, v39 row_shr:1 row_mask:0xf bank_mask:0xf
  s_nop 1
  v_add_u32_dpp v39, v39, v39 row_shr:2 row_mask:0xf bank_mask:0xf
  s_nop 1
  v_add_u32_dpp v39, v39, v39 row_shr:4 row_mask:0xf bank_mask:0xf
  s_nop 1
  v_add_u32_dpp v39, v39, v39 row_shr:8 row_mask:0xf bank_mask:0xf
  s_nop 1
  v_add_u32_dpp v39, v39, v39 row_bcast:15 row_mask:0xa bank_mask:0xf
  s_nop 1
  v_add_u32_dpp v39, v39, v39 row_bcast:31 row_mask:0xc bank_mask:0xf
  s_nop 1
  v_sub_u32 v40, v39, v40
  v_lshlrev_b32 v40, 7, v40
  v_add_u32 v40, 126976, v40
  ds_write_b32 v38, v40 offset:1408
  v_readlane_b32 s92, v39, 19
  ds_read_b32 v28, v28 offset:1408
  ds_read_b32 v29, v29 offset:1408
  ds_read_b32 v30, v30 offset:1408
  s_cmp_le_u32 s92, 284
  s_cbranch_scc1 L_fits_60
  v_mov_b32 v21, 1
  ds_write_b32 v248, v21 offset:3864
L_fits_60:
  s_waitcnt lgkmcnt(0)
  v_and_b32 v21, 7, v32
  v_lshl_add_u32 v21, v21, 3, v28
  ds_write_b32 v19, v21 offset:1536
  v_and_b32 v21, 7, v33
  v_lshl_add_u32 v21, v21, 3, v29
  ds_write_b32 v19, v21 offset:1792
  v_and_b32 v21, 7, v34
  v_lshl_add_u32 v21, v21, 3, v30
  ds_write_b32 v19, v21 offset:2048
  v_mov_b32 v20, 1
  s_mov_b64 exec, 1
  ds_add_u32 v248, v20 offset:3856
  s_mov_b64 exec, -1
  s_branch L_e_wait
L_e_prefill:
  s_mov_b32 s96, 0
L_spin_61:
  ds_read_b32 v20, v248 offset:3844
  s_waitcnt lgkmcnt(0)
  v_readfirstlane_b32 s92, v20
  s_add_u32 s96, s96, 1
  s_cmp_ge_u32 s92, 4
  s_cbranch_scc1 L_spind_62
  s_sleep 1
  s_cmp_lt_u32 s96, 0x40000
  s_cbranch_scc1 L_spin_61
L_spind_62:
  s_sub_u32 s92, s40, 5
  s_lshl_b32 s92, s92, 10
  s_add_u32 s92, s92, 126976
  v_lshlrev_b32 v20, 4, v1
  v_add_u32 v20, s92, v20
  v_mov_b32 v24, 2560000
  v_mov_b32 v25, 0
  v_mov_b32 v26, 2560000
  v_mov_b32 v27, 0
  ds_write_b128 v20, v[24:27] offset:0
  ds_write_b128 v20, v[24:27] offset:3072
  ds_write_b128 v20, v[24:27] offset:6144
  ds_write_b128 v20, v[24:27] offset:9216
  ds_write_b128 v20, v[24:27] offset:12288
  ds_write_b128 v20, v[24:27] offset:15360
  ds_write_b128 v20, v[24:27] offset:18432
  ds_write_b128 v20, v[24:27] offset:21504
  ds_write_b128 v20, v[24:27] offset:24576
  ds_write_b128 v20, v[24:27] offset:27648
  ds_write_b128 v20, v[24:27] offset:30720
  ds_write_b128 v20, v[24:27] offset:33792
  v_mov_b32 v21, 1
  s_mov_b64 exec, 1
  ds_add_u32 v248, v21 offset:3860
  s_mov_b64 exec, -1
L_e_wait:
  s_mov_b32 s96, 0
L_spin_63:
  ds_read_b32 v20, v248 offset:3856
  s_waitcnt lgkmcnt(0)
  v_readfirstlane_b32 s92, v20
  s_add_u32 s96, s96, 1
  s_cmp_ge_u32 s92, 1
  s_cbranch_scc1 L_spind_64
  s_sleep 1
  s_cmp_lt_u32 s96, 0x40000
  s_cbranch_scc1 L_spin_63
L_spind_64:
  s_mov_b32 s96, 0
L_spin_65:
  ds_read_b32 v20, v248 offset:3860
  s_waitcnt lgkmcnt(0)
  v_readfirstlane_b32 s92, v20
  s_add_u32 s96, s96, 1
  s_cmp_ge_u32 s92, 3
  s_cbranch_scc1 L_spind_66
  s_sleep 1
  s_cmp_lt_u32 s96, 0x40000
  s_cbranch_scc1 L_spin_65
L_spind_66:
  ds_read_b32 v20, v248 offset:3864
  s_waitcnt lgkmcnt(0)
  v_readfirstlane_b32 s92, v20
  s_cmp_lg_u32 s92, 0
  s_cbranch_scc1 L_e_done
  v_cmpx_lt_u32 vcc, v178, v65
  v_lshlrev_b32_sdwa v20, 2, v80 dst_sel:DWORD dst_unused:UNUSED_PAD src0_sel:DWORD src1_sel:BYTE_0
  ds_read_b32 v144, v20 offset:1536
  v_cmpx_lt_u32 vcc, v179, v65
  v_lshlrev_b32_sdwa v20, 2, v82 dst_sel:DWORD dst_unused:UNUSED_PAD src0_sel:DWORD src1_sel:BYTE_0
  ds_read_b32 v145, v20 offset:1536
  s_mov_b64 exec, -1
  v_cmp_lt_u32 vcc, 16, v65
  s_cbranch_vccz L_st1_67
  v_cmpx_lt_u32 vcc, v180, v65
  v_lshlrev_b32_sdwa v20, 2, v112 dst_sel:DWORD dst_unused:UNUSED_PAD src0_sel:DWORD src1_sel:BYTE_0
  ds_read_b32 v146, v20 offset:1536
  v_cmpx_lt_u32 vcc, v181, v65
  v_lshlrev_b32_sdwa v20, 2, v114 dst_sel:DWORD dst_unused:UNUSED_PAD src0_sel:DWORD src1_sel:BYTE_0
  ds_read_b32 v147, v20 offset:1536
  s_mov_b64 exec, -1
L_st1_67:
  v_cmpx_lt_u32 vcc, v178, v67
  v_lshlrev_b32_sdwa v20, 2, v84 dst_sel:DWORD dst_unused:UNUSED_PAD src0_sel:DWORD src1_sel:BYTE_0
  ds_read_b32 v148, v20 offset:1536
  v_cmpx_lt_u32 vcc, v179, v67
  v_lshlrev_b32_sdwa v20, 2, v86 dst_sel:DWORD dst_unused:UNUSED_PAD src0_sel:DWORD src1_sel:BYTE_0
  ds_read_b32 v149, v20 offset:1536
  s_mov_b64 exec, -1
  v_cmp_lt_u32 vcc, 16, v67
  s_cbranch_vccz L_st1_68
  v_cmpx_lt_u32 vcc, v180, v67
  v_lshlrev_b32_sdwa v20, 2, v116 dst_sel:DWORD dst_unused:UNUSED_PAD src0_sel:DWORD src1_sel:BYTE_0
  ds_read_b32 v150, v20 offset:1536
  v_cmpx_lt_u32 vcc, v181, v67
  v_lshlrev_b32_sdwa v20, 2, v118 dst_sel:DWORD dst_unused:UNUSED_PAD src0_sel:DWORD src1_sel:BYTE_0
  ds_read_b32 v151, v20 offset:1536
  s_mov_b64 exec, -1
L_st1_68:
  v_cmpx_lt_u32 vcc, v178, v69
  v_lshlrev_b32_sdwa v20, 2, v88 dst_sel:DWORD dst_unused:UNUSED_PAD src0_sel:DWORD src1_sel:BYTE_0
  ds_read_b32 v152, v20 offset:1536
  v_cmpx_lt_u32 vcc, v179, v69
  v_lshlrev_b32_sdwa v20, 2, v90 dst_sel:DWORD dst_unused:UNUSED_PAD src0_sel:DWORD src1_sel:BYTE_0
  ds_read_b32 v153, v20 offset:1536
  s_mov_b64 exec, -1
  v_cmp_lt_u32 vcc, 16, v69
  s_cbranch_vccz L_st1_69
  v_cmpx_lt_u32 vcc, v180, v69
  v_lshlrev_b32_sdwa v20, 2, v120 dst_sel:DWORD dst_unused:UNUSED_PAD src0_sel:DWORD src1_sel:BYTE_0
  ds_read_b32 v154, v20 offset:1536
  v_cmpx_lt_u32 vcc, v181, v69
  v_lshlrev_b32_sdwa v20, 2, v122 dst_sel:DWORD dst_unused:UNUSED_PAD src0_sel:DWORD src1_sel:BYTE_0
  ds_read_b32 v155, v20 offset:1536
  s_mov_b64 exec, -1
L_st1_69:
  v_cmpx_lt_u32 vcc, v178, v71
  v_lshlrev_b32_sdwa v20, 2, v92 dst_sel:DWORD dst_unused:UNUSED_PAD src0_sel:DWORD src1_sel:BYTE_0
  ds_read_b32 v156, v20 offset:1536
  v_cmpx_lt_u32 vcc, v179, v71
  v_lshlrev_b32_sdwa v20, 2, v94 dst_sel:DWORD dst_unused:UNUSED_PAD src0_sel:DWORD src1_sel:BYTE_0
  ds_read_b32 v157, v20 offset:1536
  s_mov_b64 exec, -1
  v_cmp_lt_u32 vcc, 16, v71
  s_cbranch_vccz L_st1_70
  v_cmpx_lt_u32 vcc, v180, v71
  v_lshlrev_b32_sdwa v20, 2, v124 dst_sel:DWORD dst_unused:UNUSED_PAD src0_sel:DWORD src1_sel:BYTE_0
  ds_read_b32 v158, v20 offset:1536
  v_cmpx_lt_u32 vcc, v181, v71
  v_lshlrev_b32_sdwa v20, 2, v126 dst_sel:DWORD dst_unused:UNUSED_PAD src0_sel:DWORD src1_sel:BYTE_0
  ds_read_b32 v159, v20 offset:1536
  s_mov_b64 exec, -1
L_st1_70:
  v_cmpx_lt_u32 vcc, v178, v73
  v_lshlrev_b32_sdwa v20, 2, v96 dst_sel:DWORD dst_unused:UNUSED_PAD src0_sel:DWORD src1_sel:BYTE_0
  ds_read_b32 v160, v20 offset:1536
  v_cmpx_lt_u32 vcc, v179, v73
  v_lshlrev_b32_sdwa v20, 2, v98 dst_sel:DWORD dst_unused:UNUSED_PAD src0_sel:DWORD src1_sel:BYTE_0
  ds_read_b32 v161, v20 offset:1536
  s_mov_b64 exec, -1
  v_cmp_lt_u32 vcc, 16, v73
  s_cbranch_vccz L_st1_71
  v_cmpx_lt_u32 vcc, v180, v73
  v_lshlrev_b32_sdwa v20, 2, v128 dst_sel:DWORD dst_unused:UNUSED_PAD src0_sel:DWORD src1_sel:BYTE_0
  ds_read_b32 v162, v20 offset:1536
  v_cmpx_lt_u32 vcc, v181, v73
  v_lshlrev_b32_sdwa v20, 2, v130 dst_sel:DWORD dst_unused:UNUSED_PAD src0_sel:DWORD src1_sel:BYTE_0
  ds_read_b32 v163, v20 offset:1536
  s_mov_b64 exec, -1
L_st1_71:
  v_cmpx_lt_u32 vcc, v178, v75
  v_lshlrev_b32_sdwa v20, 2, v100 dst_sel:DWORD dst_unused:UNUSED_PAD src0_sel:DWORD src1_sel:BYTE_0
  ds_read_b32 v164, v20 offset:1536
  v_cmpx_lt_u32 vcc, v179, v75
  v_lshlrev_b32_sdwa v20, 2, v102 dst_sel:DWORD dst_unused:UNUSED_PAD src0_sel:DWORD src1_sel:BYTE_0
  ds_read_b32 v165, v20 offset:1536
  s_mov_b64 exec, -1
  v_cmp_lt_u32 vcc, 16, v75
  s_cbranch_vccz L_st1_72
  v_cmpx_lt_u32 vcc, v180, v75
  v_lshlrev_b32_sdwa v20, 2, v132 dst_sel:DWORD dst_unused:UNUSED_PAD src0_sel:DWORD src1_sel:BYTE_0
  ds_read_b32 v166, v20 offset:1536
  v_cmpx_lt_u32 vcc, v181, v75
  v_lshlrev_b32_sdwa v20, 2, v134 dst_sel:DWORD dst_unused:UNUSED_PAD src0_sel:DWORD src1_sel:BYTE_0
  ds_read_b32 v167, v20 offset:1536
  s_mov_b64 exec, -1
L_st1_72:
  v_cmpx_lt_u32 vcc, v178, v77
  v_lshlrev_b32_sdwa v20, 2, v104 dst_sel:DWORD dst_unused:UNUSED_PAD src0_sel:DWORD src1_sel:BYTE_0
  ds_read_b32 v168, v20 offset:1536
  v_cmpx_lt_u32 vcc, v179, v77
  v_lshlrev_b32_sdwa v20, 2, v106 dst_sel:DWORD dst_unused:UNUSED_PAD src0_sel:DWORD src1_sel:BYTE_0
  ds_read_b32 v169, v20 offset:1536
  s_mov_b64 exec, -1
  v_cmp_lt_u32 vcc, 16, v77
  s_cbranch_vccz L_st1_73
  v_cmpx_lt_u32 vcc, v180, v77
  v_lshlrev_b32_sdwa v20, 2, v136 dst_sel:DWORD dst_unused:UNUSED_PAD src0_sel:DWORD src1_sel:BYTE_0
  ds_read_b32 v170, v20 offset:1536
  v_cmpx_lt_u32 vcc, v181, v77
  v_lshlrev_b32_sdwa v20, 2, v138 dst_sel:DWORD dst_unused:UNUSED_PAD src0_sel:DWORD src1_sel:BYTE_0
  ds_read_b32 v171, v20 offset:1536
  s_mov_b64 exec, -1
L_st1_73:
  v_cmpx_lt_u32 vcc, v178, v79
  v_lshlrev_b32_sdwa v20, 2, v108 dst_sel:DWORD dst_unused:UNUSED_PAD src0_sel:DWORD src1_sel:BYTE_0
  ds_read_b32 v172, v20 offset:1536
  v_cmpx_lt_u32 vcc, v179, v79
  v_lshlrev_b32_sdwa v20, 2, v110 dst_sel:DWORD dst_unused:UNUSED_PAD src0_sel:DWORD src1_sel:BYTE_0
  ds_read_b32 v173, v20 offset:1536
  s_mov_b64 exec, -1
  v_cmp_lt_u32 vcc, 16, v79
  s_cbranch_vccz L_st1_74
  v_cmpx_lt_u32 vcc, v180, v79
  v_lshlrev_b32_sdwa v20, 2, v140 dst_sel:DWORD dst_unused:UNUSED_PAD src0_sel:DWORD src1_sel:BYTE_0
  ds_read_b32 v174, v20 offset:1536
  v_cmpx_lt_u32 vcc, v181, v79
  v_lshlrev_b32_sdwa v20, 2, v142 dst_sel:DWORD dst_unused:UNUSED_PAD src0_sel:DWORD src1_sel:BYTE_0
  ds_read_b32 v175, v20 offset:1536
  s_mov_b64 exec, -1
L_st1_74:
  s_waitcnt lgkmcnt(0)
  v_mov_b32 v24, 0xffff0000
  v_cmpx_lt_u32 vcc, v178, v65
  v_lshl_add_u32 v144, v200, 6, v144
  v_and_b32 v81, v24, v81
  ds_write_b64 v144, v[80:81]
  v_cmpx_lt_u32 vcc, v179, v65
  v_lshl_add_u32 v145, v201, 6, v145
  v_and_b32 v83, v24, v83
  ds_write_b64 v145, v[82:83]
  s_mov_b64 exec, -1
  v_cmp_lt_u32 vcc, 16, v65
  s_cbranch_vccz L_st1_75
  v_cmpx_lt_u32 vcc, v180, v65
  v_lshl_add_u32 v146, v202, 6, v146
  v_and_b32 v113, v24, v113
  ds_write_b64 v146, v[112:113]
  v_cmpx_lt_u32 vcc, v181, v65
  v_lshl_add_u32 v147, v203, 6, v147
  v_and_b32 v115, v24, v115
  ds_write_b64 v147, v[114:115]
  s_mov_b64 exec, -1
L_st1_75:
  v_cmpx_lt_u32 vcc, v178, v67
  v_lshl_add_u32 v148, v204, 6, v148
  v_and_b32 v85, v24, v85
  ds_write_b64 v148, v[84:85]
  v_cmpx_lt_u32 vcc, v179, v67
  v_lshl_add_u32 v149, v205, 6, v149
  v_and_b32 v87, v24, v87
  ds_write_b64 v149, v[86:87]
  s_mov_b64 exec, -1
  v_cmp_lt_u32 vcc, 16, v67
  s_cbranch_vccz L_st1_76
  v_cmpx_lt_u32 vcc, v180, v67
  v_lshl_add_u32 v150, v206, 6, v150
  v_and_b32 v117, v24, v117
  ds_write_b64 v150, v[116:117]
  v_cmpx_lt_u32 vcc, v181, v67
  v_lshl_add_u32 v151, v207, 6, v151
  v_and_b32 v119, v24, v119
  ds_write_b64 v151, v[118:119]
  s_mov_b64 exec, -1
L_st1_76:
  v_cmpx_lt_u32 vcc, v178, v69
  v_lshl_add_u32 v152, v208, 6, v152
  v_and_b32 v89, v24, v89
  ds_write_b64 v152, v[88:89]
  v_cmpx_lt_u32 vcc, v179, v69
  v_lshl_add_u32 v153, v209, 6, v153
  v_and_b32 v91, v24, v91
  ds_write_b64 v153, v[90:91]
  s_mov_b64 exec, -1
  v_cmp_lt_u32 vcc, 16, v69
  s_cbranch_vccz L_st1_77
  v_cmpx_lt_u32 vcc, v180, v69
  v_lshl_add_u32 v154, v210, 6, v154
  v_and_b32 v121, v24, v121
  ds_write_b64 v154, v[120:121]
  v_cmpx_lt_u32 vcc, v181, v69
  v_lshl_add_u32 v155, v211, 6, v155
  v_and_b32 v123, v24, v123
  ds_write_b64 v155, v[122:123]
  s_mov_b64 exec, -1
L_st1_77:
  v_cmpx_lt_u32 vcc, v178, v71
  v_lshl_add_u32 v156, v212, 6, v156
  v_and_b32 v93, v24, v93
  ds_write_b64 v156, v[92:93]
  v_cmpx_lt_u32 vcc, v179, v71
  v_lshl_add_u32 v157, v213, 6, v157
  v_and_b32 v95, v24, v95
  ds_write_b64 v157, v[94:95]
  s_mov_b64 exec, -1
  v_cmp_lt_u32 vcc, 16, v71
  s_cbranch_vccz L_st1_78
  v_cmpx_lt_u32 vcc, v180, v71
  v_lshl_add_u32 v158, v214, 6, v158
  v_and_b32 v125, v24, v125
  ds_write_b64 v158, v[124:125]
  v_cmpx_lt_u32 vcc, v181, v71
  v_lshl_add_u32 v159, v215, 6, v159
  v_and_b32 v127, v24, v127
  ds_write_b64 v159, v[126:127]
  s_mov_b64 exec, -1
L_st1_78:
  v_cmpx_lt_u32 vcc, v178, v73
  v_lshl_add_u32 v160, v216, 6, v160
  v_and_b32 v97, v24, v97
  ds_write_b64 v160, v[96:97]
  v_cmpx_lt_u32 vcc, v179, v73
  v_lshl_add_u32 v161, v217, 6, v161
  v_and_b32 v99, v24, v99
  ds_write_b64 v161, v[98:99]
  s_mov_b64 exec, -1
  v_cmp_lt_u32 vcc, 16, v73
  s_cbranch_vccz L_st1_79
  v_cmpx_lt_u32 vcc, v180, v73
  v_lshl_add_u32 v162, v218, 6, v162
  v_and_b32 v129, v24, v129
  ds_write_b64 v162, v[128:129]
  v_cmpx_lt_u32 vcc, v181, v73
  v_lshl_add_u32 v163, v219, 6, v163
  v_and_b32 v131, v24, v131
  ds_write_b64 v163, v[130:131]
  s_mov_b64 exec, -1
L_st1_79:
  v_cmpx_lt_u32 vcc, v178, v75
  v_lshl_add_u32 v164, v220, 6, v164
  v_and_b32 v101, v24, v101
  ds_write_b64 v164, v[100:101]
  v_cmpx_lt_u32 vcc, v179, v75
  v_lshl_add_u32 v165, v221, 6, v165
  v_and_b32 v103, v24, v103
  ds_write_b64 v165, v[102:103]
  s_mov_b64 exec, -1
  v_cmp_lt_u32 vcc, 16, v75
  s_cbranch_vccz L_st1_80
  v_cmpx_lt_u32 vcc, v180, v75
  v_lshl_add_u32 v166, v222, 6, v166
  v_and_b32 v133, v24, v133
  ds_write_b64 v166, v[132:133]
  v_cmpx_lt_u32 vcc, v181, v75
  v_lshl_add_u32 v167, v223, 6, v167
  v_and_b32 v135, v24, v135
  ds_write_b64 v167, v[134:135]
  s_mov_b64 exec, -1
L_st1_80:
  v_cmpx_lt_u32 vcc, v178, v77
  v_lshl_add_u32 v168, v224, 6, v168
  v_and_b32 v105, v24, v105
  ds_write_b64 v168, v[104:105]
  v_cmpx_lt_u32 vcc, v179, v77
  v_lshl_add_u32 v169, v225, 6, v169
  v_and_b32 v107, v24, v107
  ds_write_b64 v169, v[106:107]
  s_mov_b64 exec, -1
  v_cmp_lt_u32 vcc, 16, v77
  s_cbranch_vccz L_st1_81
  v_cmpx_lt_u32 vcc, v180, v77
  v_lshl_add_u32 v170, v226, 6, v170
  v_and_b32 v137, v24, v137
  ds_write_b64 v170, v[136:137]
  v_cmpx_lt_u32 vcc, v181, v77
  v_lshl_add_u32 v171, v227, 6, v171
  v_and_b32 v139, v24, v139
  ds_write_b64 v171, v[138:139]
  s_mov_b64 exec, -1
L_st1_81:
  v_cmpx_lt_u32 vcc, v178, v79
  v_lshl_add_u32 v172, v228, 6, v172
  v_and_b32 v109, v24, v109
  ds_write_b64 v172, v[108:109]
  v_cmpx_lt_u32 vcc, v179, v79
  v_lshl_add_u32 v173, v229, 6, v173
  v_and_b32 v111, v24, v111
  ds_write_b64 v173, v[110:111]
  s_mov_b64 exec, -1
  v_cmp_lt_u32 vcc, 16, v79
  s_cbranch_vccz L_st1_82
  v_cmpx_lt_u32 vcc, v180, v79
  v_lshl_add_u32 v174, v230, 6, v174
  v_and_b32 v141, v24, v141
  ds_write_b64 v174, v[140:141]
  v_cmpx_lt_u32 vcc, v181, v79
  v_lshl_add_u32 v175, v231, 6, v175
  v_and_b32 v143, v24, v143
  ds_write_b64 v175, v[142:143]
  s_mov_b64 exec, -1
L_st1_82:
L_e_done:
  s_waitcnt lgkmcnt(0)
  s_cmp_lg_u32 s40, 4
  s_cbranch_scc1 L_main_setup
  v_lshlrev_b32 v20, 4, v1
  s_lshl_b32 s95, s41, 10
  s_add_u32 s95, s95, 131072
  s_mov_b32 s96, 0
L_poll2_83:
  buffer_load_dword v21, v20, s[84:87], s95 offen sc1
  s_waitcnt vmcnt(0)
  v_cmp_ne_u32 vcc, s43, v21
  s_cbranch_vccz L_poll2d_84
  s_sleep 2
  s_add_u32 s96, s96, 1
  s_cmp_lt_u32 s96, 0x10000
  s_cbranch_scc1 L_poll2_83
L_poll2d_84:
  s_cmp_lg_u32 s2, 0
  s_cbranch_scc1 L_noep_85
  s_mov_b64 exec, 1
  v_mov_b32 v21, s43
  global_store_dword v248, v21, s[4:5] sc1
  s_mov_b64 exec, -1
L_noep_85:
L_main_setup:
  s_setprio 0
  v_and_b32 v2, 7, v1
  v_lshlrev_b32 v2, 4, v2
  v_bfe_u32 v196, v1, 3, 2
  v_bfe_u32 v197, v1, 2, 1
  v_lshrrev_b32 v198, 5, v1
  v_and_b32 v199, 3, v1
  v_cmp_eq_u32 vcc, v197, v198
  v_mov_b32 v195, 7
  v_and_b32 v193, 1, v196
  v_cndmask_b32 v199, v195, v199, vcc
  v_cmp_gt_u32 vcc, 2, v196
  v_mov_b32 v194, 0x3f80
  v_mov_b32 v195, 0x3f800000
  v_cndmask_b32 v192, v194, v195, vcc
  v_cndmask_b32 v191, v195, v194, vcc
  v_lshl_add_u32 v199, v193, 3, v199
  v_cmp_eq_u32 vcc, 0, v199
  v_cmp_eq_u32 s[98:99], 8, v199
  s_nop 0
  v_cndmask_b32 v4, 0, v192, vcc
  v_cndmask_b32 v12, 0, v191, vcc
  v_cndmask_b32 v8, 0, v192, s[98:99]
  v_cndmask_b32 v16, 0, v191, s[98:99]
  v_cmp_eq_u32 vcc, 1, v199
  v_cmp_eq_u32 s[98:99], 9, v199
  s_nop 0
  v_cndmask_b32 v5, 0, v192, vcc
  v_cndmask_b32 v13, 0, v191, vcc
  v_cndmask_b32 v9, 0, v192, s[98:99]
  v_cndmask_b32 v17, 0, v191, s[98:99]
  v_cmp_eq_u32 vcc, 2, v199
  v_cmp_eq_u32 s[98:99], 10, v199
  s_nop 0
  v_cndmask_b32 v6, 0, v192, vcc
  v_cndmask_b32 v14, 0, v191, vcc
  v_cndmask_b32 v10, 0, v192, s[98:99]
  v_cndmask_b32 v18, 0, v191, s[98:99]
  v_cmp_eq_u32 vcc, 3, v199
  v_cmp_eq_u32 s[98:99], 11, v199
  s_nop 0
  v_cndmask_b32 v7, 0, v192, vcc
  v_cndmask_b32 v15, 0, v191, vcc
  v_cndmask_b32 v11, 0, v192, s[98:99]
  v_cndmask_b32 v19, 0, v191, s[98:99]
  v_cmp_gt_u32 vcc, 32, v1
  v_mov_b32 v21, 0
  v_mov_b32 v22, 0
  v_mov_b32 v23, 0
  v_cndmask_b32 v20, 0, v194, vcc
  v_lshlrev_b32 v24, 16, v250
  v_and_b32 v25, 0xffff0000, v250
  v_lshlrev_b32 v26, 16, v251
  v_and_b32 v27, 0xffff0000, v251
  v_lshlrev_b32 v28, 16, v252
  v_and_b32 v29, 0xffff0000, v252
  v_lshlrev_b32 v30, 16, v253
  v_and_b32 v31, 0xffff0000, v253
  v_mul_f32 v24, 0xbfb8aa3b, v24
  v_mul_f32 v25, 0xbfb8aa3b, v25
  v_mul_f32 v26, 0xbfb8aa3b, v26
  v_mul_f32 v27, 0xbfb8aa3b, v27
  v_mul_f32 v28, 0xbfb8aa3b, v28
  v_mul_f32 v29, 0xbfb8aa3b, v29
  v_mul_f32 v30, 0xbfb8aa3b, v30
  v_mul_f32 v31, 0xbfb8aa3b, v31
  v_mov_b32 v48, 0
  v_mov_b32 v64, 0
  v_mov_b32 v49, 0
  v_mov_b32 v65, 0
  v_mov_b32 v50, 0
  v_mov_b32 v66, 0
  v_mov_b32 v51, 0
  v_mov_b32 v67, 0
  v_mov_b32 v52, 0
  v_mov_b32 v68, 0
  v_mov_b32 v53, 0
  v_mov_b32 v69, 0
  v_mov_b32 v54, 0
  v_mov_b32 v70, 0
  v_mov_b32 v55, 0
  v_mov_b32 v71, 0
  v_add_u32 v210, 86016, v2
  v_bfe_u32 v214, v1, 1, 2
  s_lshl_b32 s92, s41, 3
  v_add_u32 v214, s92, v214
  v_lshlrev_b32 v214, 4, v214
  v_and_b32 v215, 1, v1
  v_lshl_add_u32 v211, v215, 3, v214
  s_lshl_b32 s92, s44, 9
  s_lshl_b32 s93, s41, 7
  s_add_u32 s92, s92, s93
  v_lshrrev_b32 v214, 1, v2
  v_add_u32 v212, s92, v214
  v_lshrrev_b32 v216, 3, v1
  v_lshlrev_b32 v216, 3, v216
  s_sub_u32 s12, 19, s40
  s_cmp_lt_u32 s40, 4
  s_cselect_b32 s12, s40, s12
  s_add_u32 s46, s40, 4
  s_sub_u32 s92, 23, s40
  s_sub_u32 s13, 11, s40
  s_cmp_ge_u32 s40, 4
  s_cselect_b32 s46, s92, s46
  s_cselect_b32 s13, -1, s13
  s_xor_b32 s15, s42, 1
  s_mul_i32 s15, s15, 40192
  s_mul_i32 s92, s40, 5120
  s_add_u32 s15, s15, s92
  v_lshlrev_b32 v218, 4, v1
  s_waitcnt lgkmcnt(0)
  s_barrier
  ds_read_b32 v219, v248 offset:3864
  s_lshl_b32 s92, s12, 2
  v_mov_b32 v220, s92
  ds_read_b32 v3, v220 offset:1408
  s_lshl_b32 s92, s12, 6
  v_add_u32 v214, s92, v216
  ds_read_b64 v[178:179], v214 offset:2304
  s_lshl_b32 s92, s12, 2
  v_mov_b32 v215, s92
  ds_read_b32 v180, v215 offset:1280
  s_cmp_ge_u32 s40, 4
  s_cbranch_scc1 L_ap_86
  s_setprio 1
L_ap_86:
  s_waitcnt lgkmcnt(0)
  v_readfirstlane_b32 s92, v219
  s_cmp_lg_u32 s92, 0
  s_cbranch_scc1 L_fallback
  v_add_u32 v3, v3, v216
  v_readfirstlane_b32 s14, v180
  ds_read2_b32 v[168:169], v3 offset0:0 offset1:16
  ds_read2_b32 v[170:171], v3 offset0:32 offset1:48
  v_lshl_add_u32 v214, v178, 8, v210
  v_xor_b32 v215, v179, v211
  v_xor_b32 v217, 64, v215
  ds_read_b128 v[182:185], v214
  ds_read_b128 v[186:189], v214 offset:128
  ds_read_b64 v[190:191], v215 offset:4096
  ds_read_b64 v[192:193], v217 offset:4096
  s_waitcnt lgkmcnt(4)
  v_and_or_b32 v176, v168, s10, v2
  v_and_or_b32 v177, v169, s10, v2
  buffer_load_dwordx4 v[136:139], v176, s[76:79], 0 offen sc1
  buffer_load_dwordx4 v[140:143], v176, s[76:79], 0 offen offset:128 sc1
  buffer_load_dwordx4 v[144:147], v177, s[76:79], 0 offen sc1
  buffer_load_dwordx4 v[148:151], v177, s[76:79], 0 offen offset:128 sc1
  v_and_or_b32 v176, v170, s10, v2
  v_and_or_b32 v177, v171, s10, v2
  buffer_load_dwordx4 v[152:155], v176, s[76:79], 0 offen sc1
  buffer_load_dwordx4 v[156:159], v176, s[76:79], 0 offen offset:128 sc1
  buffer_load_dwordx4 v[160:163], v177, s[76:79], 0 offen sc1
  buffer_load_dwordx4 v[164:167], v177, s[76:79], 0 offen offset:128 sc1
  ds_read2_b32 v[168:169], v3 offset0:64 offset1:80
  ds_read2_b32 v[172:173], v3 offset0:1 offset1:17
  s_mov_b32 s97, 0
L_group:
  s_min_u32 s14, s14, 576
  s_and_b32 s96, s14, 1
  s_add_u32 s47, s14, 1
  s_lshr_b32 s47, s47, 1
  v_lshl_add_u32 v181, v178, 9, v212
  v_mfma_f32_32x32x16_bf16 v[32:47], v[48:51], v[48:51], 0
  s_waitcnt lgkmcnt(0)
  v_lshlrev_b32 v56, 16, v182
  v_lshlrev_b32 v57, 16, v183
  v_lshlrev_b32 v58, 16, v184
  v_lshlrev_b32 v59, 16, v185
  v_lshlrev_b32 v60, 16, v186
  v_lshlrev_b32 v61, 16, v187
  v_lshlrev_b32 v62, 16, v188
  v_lshlrev_b32 v63, 16, v189
  s_cmp_eq_u32 s46, -1
  s_cbranch_scc1 L_nonext_87
  s_lshl_b32 s92, s46, 6
  v_add_u32 v214, s92, v216
  ds_read_b64 v[178:179], v214 offset:2304
  s_lshl_b32 s92, s46, 2
  v_mov_b32 v215, s92
  ds_read_b32 v180, v215 offset:1280
L_nonext_87:
  v_and_b32 v194, 0xffff0000, v182
  v_and_b32 v195, 0xffff0000, v183
  v_and_b32 v196, 0xffff0000, v184
  v_and_b32 v197, 0xffff0000, v185
  v_and_b32 v198, 0xffff0000, v186
  v_and_b32 v199, 0xffff0000, v187
  v_and_b32 v200, 0xffff0000, v188
  v_and_b32 v201, 0xffff0000, v189
  v_lshlrev_b32 v202, 16, v190
  v_and_b32 v203, 0xffff0000, v190
  v_lshlrev_b32 v204, 16, v191
  v_and_b32 v205, 0xffff0000, v191
  v_lshlrev_b32 v206, 16, v192
  v_and_b32 v207, 0xffff0000, v192
  v_lshlrev_b32 v208, 16, v193
  v_and_b32 v209, 0xffff0000, v193
  s_cmp_eq_u32 s47, 0
  s_cbranch_scc1 L_epi
  s_cmp_eq_u32 s97, 1
  s_cbranch_scc1 L_gs1
L_gs0:
  s_waitcnt vmcnt(4)
  v_mfma_f32_32x32x16_bf16 v[72:87], v[4:7], v[136:139], v[48:63]
  v_mfma_f32_32x32x16_bf16 v[72:87], v[8:11], v[140:143], v[72:87]
  v_mfma_f32_32x32x16_bf16 v[88:103], v[12:15], v[144:147], v[56:71]
  v_mfma_f32_32x32x16_bf16 v[88:103], v[16:19], v[148:151], v[88:103]
  s_waitcnt lgkmcnt(0)
  v_and_or_b32 v176, v168, s10, v2
  v_and_or_b32 v177, v169, s10, v2
  buffer_load_dwordx4 v[136:139], v176, s[76:79], 0 offen sc1
  buffer_load_dwordx4 v[140:143], v176, s[76:79], 0 offen offset:128 sc1
  buffer_load_dwordx4 v[144:147], v177, s[76:79], 0 offen sc1
  buffer_load_dwordx4 v[148:151], v177, s[76:79], 0 offen offset:128 sc1
  ds_read2_b32 v[170:171], v3 offset0:96 offset1:112
  ds_read2_b32 v[174:175], v3 offset0:33 offset1:49
  s_nop 7
  v_pk_fma_f32 v[80:81], v[172:173], v[24:25], v[80:81] op_sel:[0,0,0] op_sel_hi:[0,1,1]
  v_pk_fma_f32 v[82:83], v[172:173], v[26:27], v[82:83] op_sel:[0,0,0] op_sel_hi:[0,1,1]
  v_pk_fma_f32 v[84:85], v[172:173], v[28:29], v[84:85] op_sel:[0,0,0] op_sel_hi:[0,1,1]
  v_pk_fma_f32 v[86:87], v[172:173], v[30:31], v[86:87] op_sel:[0,0,0] op_sel_hi:[0,1,1]
  v_pk_fma_f32 v[88:89], v[172:173], v[24:25], v[88:89] op_sel:[1,0,0] op_sel_hi:[1,1,1]
  v_pk_fma_f32 v[90:91], v[172:173], v[26:27], v[90:91] op_sel:[1,0,0] op_sel_hi:[1,1,1]
  v_pk_fma_f32 v[92:93], v[172:173], v[28:29], v[92:93] op_sel:[1,0,0] op_sel_hi:[1,1,1]
  v_pk_fma_f32 v[94:95], v[172:173], v[30:31], v[94:95] op_sel:[1,0,0] op_sel_hi:[1,1,1]
  s_branch L_body0
L_gs1:
  s_waitcnt vmcnt(4)
  v_mfma_f32_32x32x16_bf16 v[104:119], v[4:7], v[152:155], v[48:63]
  v_mfma_f32_32x32x16_bf16 v[104:119], v[8:11], v[156:159], v[104:119]
  v_mfma_f32_32x32x16_bf16 v[120:135], v[12:15], v[160:163], v[56:71]
  v_mfma_f32_32x32x16_bf16 v[120:135], v[16:19], v[164:167], v[120:135]
  s_waitcnt lgkmcnt(0)
  v_and_or_b32 v176, v170, s10, v2
  v_and_or_b32 v177, v171, s10, v2
  buffer_load_dwordx4 v[152:155], v176, s[76:79], 0 offen sc1
  buffer_load_dwordx4 v[156:159], v176, s[76:79], 0 offen offset:128 sc1
  buffer_load_dwordx4 v[160:163], v177, s[76:79], 0 offen sc1
  buffer_load_dwordx4 v[164:167], v177, s[76:79], 0 offen offset:128 sc1
  ds_read2_b32 v[168:169], v3 offset0:128 offset1:144
  ds_read2_b32 v[172:173], v3 offset0:65 offset1:81
  v_add_u32 v3, 256, v3
  s_nop 7
  v_pk_fma_f32 v[112:113], v[174:175], v[24:25], v[112:113] op_sel:[0,0,0] op_sel_hi:[0,1,1]
  v_pk_fma_f32 v[114:115], v[174:175], v[26:27], v[114:115] op_sel:[0,0,0] op_sel_hi:[0,1,1]
  v_pk_fma_f32 v[116:117], v[174:175], v[28:29], v[116:117] op_sel:[0,0,0] op_sel_hi:[0,1,1]
  v_pk_fma_f32 v[118:119], v[174:175], v[30:31], v[118:119] op_sel:[0,0,0] op_sel_hi:[0,1,1]
  v_pk_fma_f32 v[120:121], v[174:175], v[24:25], v[120:121] op_sel:[1,0,0] op_sel_hi:[1,1,1]
  v_pk_fma_f32 v[122:123], v[174:175], v[26:27], v[122:123] op_sel:[1,0,0] op_sel_hi:[1,1,1]
  v_pk_fma_f32 v[124:125], v[174:175], v[28:29], v[124:125] op_sel:[1,0,0] op_sel_hi:[1,1,1]
  v_pk_fma_f32 v[126:127], v[174:175], v[30:31], v[126:127] op_sel:[1,0,0] op_sel_hi:[1,1,1]
  s_branch L_body1
L_body0:
  s_sub_u32 s47, s47, 1
  s_cmp_eq_u32 s47, 0
  s_cbranch_scc1 L_last0
  s_waitcnt vmcnt(4)
  v_mfma_f32_32x32x16_bf16 v[104:119], v[4:7], v[152:155], v[48:63]
  v_exp_f32 v80, v80
  v_exp_f32 v81, v81
  v_exp_f32 v82, v82
  v_exp_f32 v83, v83
  v_mfma_f32_32x32x16_bf16 v[104:119], v[8:11], v[156:159], v[104:119]
  v_exp_f32 v84, v84
  v_exp_f32 v85, v85
  v_exp_f32 v86, v86
  v_exp_f32 v87, v87
  v_mfma_f32_32x32x16_bf16 v[120:135], v[12:15], v[160:163], v[56:71]
  v_exp_f32 v88, v88
  v_exp_f32 v89, v89
  v_exp_f32 v90, v90
  v_exp_f32 v91, v91
  v_mfma_f32_32x32x16_bf16 v[120:135], v[16:19], v[164:167], v[120:135]
  v_exp_f32 v92, v92
  v_exp_f32 v93, v93
  v_exp_f32 v94, v94
  v_exp_f32 v95, v95
  s_nop 1
  v_mfma_f32_32x32x16_bf16 v[80:95], v[20:23], v[20:23], v[80:95]
  s_waitcnt lgkmcnt(0)
  v_and_or_b32 v176, v170, s10, v2
  v_and_or_b32 v177, v171, s10, v2
  buffer_load_dwordx4 v[152:155], v176, s[76:79], 0 offen sc1
  buffer_load_dwordx4 v[156:159], v176, s[76:79], 0 offen offset:128 sc1
  buffer_load_dwordx4 v[160:163], v177, s[76:79], 0 offen sc1
  buffer_load_dwordx4 v[164:167], v177, s[76:79], 0 offen offset:128 sc1
  s_nop 2
  ds_read2_b32 v[168:169], v3 offset0:128 offset1:144
  ds_read2_b32 v[172:173], v3 offset0:65 offset1:81
  v_add_u32 v3, 256, v3
  v_rcp_f32 v80, v80
  v_rcp_f32 v81, v81
  v_rcp_f32 v82, v82
  v_rcp_f32 v83, v83
  v_rcp_f32 v84, v84
  v_rcp_f32 v85, v85
  v_rcp_f32 v86, v86
  v_rcp_f32 v87, v87
  v_rcp_f32 v88, v88
  v_rcp_f32 v89, v89
  v_rcp_f32 v90, v90
  v_rcp_f32 v91, v91
  v_rcp_f32 v92, v92
  v_rcp_f32 v93, v93
  v_rcp_f32 v94, v94
  v_rcp_f32 v95, v95
  v_pk_fma_f32 v[112:113], v[174:175], v[24:25], v[112:113] op_sel:[0,0,0] op_sel_hi:[0,1,1]
  v_pk_fma_f32 v[114:115], v[174:175], v[26:27], v[114:115] op_sel:[0,0,0] op_sel_hi:[0,1,1]
  v_pk_fma_f32 v[116:117], v[174:175], v[28:29], v[116:117] op_sel:[0,0,0] op_sel_hi:[0,1,1]
  v_pk_fma_f32 v[118:119], v[174:175], v[30:31], v[118:119] op_sel:[0,0,0] op_sel_hi:[0,1,1]
  v_pk_fma_f32 v[120:121], v[174:175], v[24:25], v[120:121] op_sel:[1,0,0] op_sel_hi:[1,1,1]
  v_pk_fma_f32 v[122:123], v[174:175], v[26:27], v[122:123] op_sel:[1,0,0] op_sel_hi:[1,1,1]
  v_pk_fma_f32 v[124:125], v[174:175], v[28:29], v[124:125] op_sel:[1,0,0] op_sel_hi:[1,1,1]
  v_pk_fma_f32 v[126:127], v[174:175], v[30:31], v[126:127] op_sel:[1,0,0] op_sel_hi:[1,1,1]
  v_pk_add_f32 v[40:41], v[40:41], v[80:81]
  v_pk_fma_f32 v[32:33], v[80:81], v[72:73], v[32:33]
  v_pk_add_f32 v[42:43], v[42:43], v[82:83]
  v_pk_fma_f32 v[34:35], v[82:83], v[74:75], v[34:35]
  v_pk_add_f32 v[44:45], v[44:45], v[84:85]
  v_pk_fma_f32 v[36:37], v[84:85], v[76:77], v[36:37]
  v_pk_add_f32 v[46:47], v[46:47], v[86:87]
  v_pk_fma_f32 v[38:39], v[86:87], v[78:79], v[38:39]
  v_pk_add_f32 v[40:41], v[40:41], v[88:89]
  v_pk_fma_f32 v[32:33], v[88:89], v[96:97], v[32:33]
  v_pk_add_f32 v[42:43], v[42:43], v[90:91]
  v_pk_fma_f32 v[34:35], v[90:91], v[98:99], v[34:35]
  v_pk_add_f32 v[44:45], v[44:45], v[92:93]
  v_pk_fma_f32 v[36:37], v[92:93], v[100:101], v[36:37]
  v_pk_add_f32 v[46:47], v[46:47], v[94:95]
  v_pk_fma_f32 v[38:39], v[94:95], v[102:103], v[38:39]
L_body1:
  s_sub_u32 s47, s47, 1
  s_cmp_eq_u32 s47, 0
  s_cbranch_scc1 L_last1
  s_waitcnt vmcnt(4)
  v_mfma_f32_32x32x16_bf16 v[72:87], v[4:7], v[136:139], v[48:63]
  v_exp_f32 v112, v112
  v_exp_f32 v113, v113
  v_exp_f32 v114, v114
  v_exp_f32 v115, v115
  v_mfma_f32_32x32x16_bf16 v[72:87], v[8:11], v[140:143], v[72:87]
  v_exp_f32 v116, v116
  v_exp_f32 v117, v117
  v_exp_f32 v118, v118
  v_exp_f32 v119, v119
  v_mfma_f32_32x32x16_bf16 v[88:103], v[12:15], v[144:147], v[56:71]
  v_exp_f32 v120, v120
  v_exp_f32 v121, v121
  v_exp_f32 v122, v122
  v_exp_f32 v123, v123
  v_mfma_f32_32x32x16_bf16 v[88:103], v[16:19], v[148:151], v[88:103]
  v_exp_f32 v124, v124
  v_exp_f32 v125, v125
  v_exp_f32 v126, v126
  v_exp_f32 v127, v127
  s_nop 1
  v_mfma_f32_32x32x16_bf16 v[112:127], v[20:23], v[20:23], v[112:127]
  s_waitcnt lgkmcnt(0)
  v_and_or_b32 v176, v168, s10, v2
  v_and_or_b32 v177, v169, s10, v2
  buffer_load_dwordx4 v[136:139], v176, s[76:79], 0 offen sc1
  buffer_load_dwordx4 v[140:143], v176, s[76:79], 0 offen offset:128 sc1
  buffer_load_dwordx4 v[144:147], v177, s[76:79], 0 offen sc1
  buffer_load_dwordx4 v[148:151], v177, s[76:79], 0 offen offset:128 sc1
  s_nop 2
  ds_read2_b32 v[170:171], v3 offset0:96 offset1:112
  ds_read2_b32 v[174:175], v3 offset0:33 offset1:49
  v_rcp_f32 v112, v112
  v_rcp_f32 v113, v113
  v_rcp_f32 v114, v114
  v_rcp_f32 v115, v115
  v_rcp_f32 v116, v116
  v_rcp_f32 v117, v117
  v_rcp_f32 v118, v118
  v_rcp_f32 v119, v119
  v_rcp_f32 v120, v120
  v_rcp_f32 v121, v121
  v_rcp_f32 v122, v122
  v_rcp_f32 v123, v123
  v_rcp_f32 v124, v124
  v_rcp_f32 v125, v125
  v_rcp_f32 v126, v126
  v_rcp_f32 v127, v127
  v_pk_fma_f32 v[80:81], v[172:173], v[24:25], v[80:81] op_sel:[0,0,0] op_sel_hi:[0,1,1]
  v_pk_fma_f32 v[82:83], v[172:173], v[26:27], v[82:83] op_sel:[0,0,0] op_sel_hi:[0,1,1]
  v_pk_fma_f32 v[84:85], v[172:173], v[28:29], v[84:85] op_sel:[0,0,0] op_sel_hi:[0,1,1]
  v_pk_fma_f32 v[86:87], v[172:173], v[30:31], v[86:87] op_sel:[0,0,0] op_sel_hi:[0,1,1]
  v_pk_fma_f32 v[88:89], v[172:173], v[24:25], v[88:89] op_sel:[1,0,0] op_sel_hi:[1,1,1]
  v_pk_fma_f32 v[90:91], v[172:173], v[26:27], v[90:91] op_sel:[1,0,0] op_sel_hi:[1,1,1]
  v_pk_fma_f32 v[92:93], v[172:173], v[28:29], v[92:93] op_sel:[1,0,0] op_sel_hi:[1,1,1]
  v_pk_fma_f32 v[94:95], v[172:173], v[30:31], v[94:95] op_sel:[1,0,0] op_sel_hi:[1,1,1]
  v_pk_add_f32 v[40:41], v[40:41], v[112:113]
  v_pk_fma_f32 v[32:33], v[112:113], v[104:105], v[32:33]
  v_pk_add_f32 v[42:43], v[42:43], v[114:115]
  v_pk_fma_f32 v[34:35], v[114:115], v[106:107], v[34:35]
  v_pk_add_f32 v[44:45], v[44:45], v[116:117]
  v_pk_fma_f32 v[36:37], v[116:117], v[108:109], v[36:37]
  v_pk_add_f32 v[46:47], v[46:47], v[118:119]
  v_pk_fma_f32 v[38:39], v[118:119], v[110:111], v[38:39]
  v_pk_add_f32 v[40:41], v[40:41], v[120:121]
  v_pk_fma_f32 v[32:33], v[120:121], v[128:129], v[32:33]
  v_pk_add_f32 v[42:43], v[42:43], v[122:123]
  v_pk_fma_f32 v[34:35], v[122:123], v[130:131], v[34:35]
  v_pk_add_f32 v[44:45], v[44:45], v[124:125]
  v_pk_fma_f32 v[36:37], v[124:125], v[132:133], v[36:37]
  v_pk_add_f32 v[46:47], v[46:47], v[126:127]
  v_pk_fma_f32 v[38:39], v[126:127], v[134:135], v[38:39]
  s_branch L_body0
L_last0:
  s_cmp_eq_u32 s96, 1
  s_cbranch_scc1 L_half0
  v_exp_f32 v80, v80
  v_exp_f32 v81, v81
  v_exp_f32 v82, v82
  v_exp_f32 v83, v83
  v_exp_f32 v84, v84
  v_exp_f32 v85, v85
  v_exp_f32 v86, v86
  v_exp_f32 v87, v87
  v_exp_f32 v88, v88
  v_exp_f32 v89, v89
  v_exp_f32 v90, v90
  v_exp_f32 v91, v91
  v_exp_f32 v92, v92
  v_exp_f32 v93, v93
  v_exp_f32 v94, v94
  v_exp_f32 v95, v95
  s_nop 1
  v_mfma_f32_32x32x16_bf16 v[80:95], v[20:23], v[20:23], v[80:95]
  s_nop 7
  s_nop 3
  v_rcp_f32 v80, v80
  v_rcp_f32 v81, v81
  v_rcp_f32 v82, v82
  v_rcp_f32 v83, v83
  v_rcp_f32 v84, v84
  v_rcp_f32 v85, v85
  v_rcp_f32 v86, v86
  v_rcp_f32 v87, v87
  v_rcp_f32 v88, v88
  v_rcp_f32 v89, v89
  v_rcp_f32 v90, v90
  v_rcp_f32 v91, v91
  v_rcp_f32 v92, v92
  v_rcp_f32 v93, v93
  v_rcp_f32 v94, v94
  v_rcp_f32 v95, v95
  v_pk_add_f32 v[40:41], v[40:41], v[80:81]
  v_pk_fma_f32 v[32:33], v[80:81], v[72:73], v[32:33]
  v_pk_add_f32 v[42:43], v[42:43], v[82:83]
  v_pk_fma_f32 v[34:35], v[82:83], v[74:75], v[34:35]
  v_pk_add_f32 v[44:45], v[44:45], v[84:85]
  v_pk_fma_f32 v[36:37], v[84:85], v[76:77], v[36:37]
  v_pk_add_f32 v[46:47], v[46:47], v[86:87]
  v_pk_fma_f32 v[38:39], v[86:87], v[78:79], v[38:39]
  v_pk_add_f32 v[40:41], v[40:41], v[88:89]
  v_pk_fma_f32 v[32:33], v[88:89], v[96:97], v[32:33]
  v_pk_add_f32 v[42:43], v[42:43], v[90:91]
  v_pk_fma_f32 v[34:35], v[90:91], v[98:99], v[34:35]
  v_pk_add_f32 v[44:45], v[44:45], v[92:93]
  v_pk_fma_f32 v[36:37], v[92:93], v[100:101], v[36:37]
  v_pk_add_f32 v[46:47], v[46:47], v[94:95]
  v_pk_fma_f32 v[38:39], v[94:95], v[102:103], v[38:39]
  s_mov_b32 s97, 1
  s_branch L_epi
L_half0:
  v_exp_f32 v80, v80
  v_exp_f32 v81, v81
  v_exp_f32 v82, v82
  v_exp_f32 v83, v83
  v_exp_f32 v84, v84
  v_exp_f32 v85, v85
  v_exp_f32 v86, v86
  v_exp_f32 v87, v87
  v_pk_add_f32 v[80:81], v[80:81], 1.0 op_sel_hi:[1,0]
  v_pk_add_f32 v[82:83], v[82:83], 1.0 op_sel_hi:[1,0]
  v_pk_add_f32 v[84:85], v[84:85], 1.0 op_sel_hi:[1,0]
  v_pk_add_f32 v[86:87], v[86:87], 1.0 op_sel_hi:[1,0]
  v_rcp_f32 v80, v80
  v_rcp_f32 v81, v81
  v_rcp_f32 v82, v82
  v_rcp_f32 v83, v83
  v_rcp_f32 v84, v84
  v_rcp_f32 v85, v85
  v_rcp_f32 v86, v86
  v_rcp_f32 v87, v87
  v_pk_add_f32 v[40:41], v[40:41], v[80:81]
  v_pk_fma_f32 v[32:33], v[80:81], v[72:73], v[32:33]
  v_pk_add_f32 v[42:43], v[42:43], v[82:83]
  v_pk_fma_f32 v[34:35], v[82:83], v[74:75], v[34:35]
  v_pk_add_f32 v[44:45], v[44:45], v[84:85]
  v_pk_fma_f32 v[36:37], v[84:85], v[76:77], v[36:37]
  v_pk_add_f32 v[46:47], v[46:47], v[86:87]
  v_pk_fma_f32 v[38:39], v[86:87], v[78:79], v[38:39]
  s_mov_b32 s97, 1
  s_branch L_epi
L_last1:
  s_cmp_eq_u32 s96, 1
  s_cbranch_scc1 L_half1
  v_exp_f32 v112, v112
  v_exp_f32 v113, v113
  v_exp_f32 v114, v114
  v_exp_f32 v115, v115
  v_exp_f32 v116, v116
  v_exp_f32 v117, v117
  v_exp_f32 v118, v118
  v_exp_f32 v119, v119
  v_exp_f32 v120, v120
  v_exp_f32 v121, v121
  v_exp_f32 v122, v122
  v_exp_f32 v123, v123
  v_exp_f32 v124, v124
  v_exp_f32 v125, v125
  v_exp_f32 v126, v126
  v_exp_f32 v127, v127
  s_nop 1
  v_mfma_f32_32x32x16_bf16 v[112:127], v[20:23], v[20:23], v[112:127]
  s_nop 7
  s_nop 3
  v_rcp_f32 v112, v112
  v_rcp_f32 v113, v113
  v_rcp_f32 v114, v114
  v_rcp_f32 v115, v115
  v_rcp_f32 v116, v116
  v_rcp_f32 v117, v117
  v_rcp_f32 v118, v118
  v_rcp_f32 v119, v119
  v_rcp_f32 v120, v120
  v_rcp_f32 v121, v121
  v_rcp_f32 v122, v122
  v_rcp_f32 v123, v123
  v_rcp_f32 v124, v124
  v_rcp_f32 v125, v125
  v_rcp_f32 v126, v126
  v_rcp_f32 v127, v127
  v_pk_add_f32 v[40:41], v[40:41], v[112:113]
  v_pk_fma_f32 v[32:33], v[112:113], v[104:105], v[32:33]
  v_pk_add_f32 v[42:43], v[42:43], v[114:115]
  v_pk_fma_f32 v[34:35], v[114:115], v[106:107], v[34:35]
  v_pk_add_f32 v[44:45], v[44:45], v[116:117]
  v_pk_fma_f32 v[36:37], v[116:117], v[108:109], v[36:37]
  v_pk_add_f32 v[46:47], v[46:47], v[118:119]
  v_pk_fma_f32 v[38:39], v[118:119], v[110:111], v[38:39]
  v_pk_add_f32 v[40:41], v[40:41], v[120:121]
  v_pk_fma_f32 v[32:33], v[120:121], v[128:129], v[32:33]
  v_pk_add_f32 v[42:43], v[42:43], v[122:123]
  v_pk_fma_f32 v[34:35], v[122:123], v[130:131], v[34:35]
  v_pk_add_f32 v[44:45], v[44:45], v[124:125]
  v_pk_fma_f32 v[36:37], v[124:125], v[132:133], v[36:37]
  v_pk_add_f32 v[46:47], v[46:47], v[126:127]
  v_pk_fma_f32 v[38:39], v[126:127], v[134:135], v[38:39]
  s_mov_b32 s97, 0
  s_branch L_epi
L_half1:
  v_exp_f32 v112, v112
  v_exp_f32 v113, v113
  v_exp_f32 v114, v114
  v_exp_f32 v115, v115
  v_exp_f32 v116, v116
  v_exp_f32 v117, v117
  v_exp_f32 v118, v118
  v_exp_f32 v119, v119
  v_pk_add_f32 v[112:113], v[112:113], 1.0 op_sel_hi:[1,0]
  v_pk_add_f32 v[114:115], v[114:115], 1.0 op_sel_hi:[1,0]
  v_pk_add_f32 v[116:117], v[116:117], 1.0 op_sel_hi:[1,0]
  v_pk_add_f32 v[118:119], v[118:119], 1.0 op_sel_hi:[1,0]
  v_rcp_f32 v112, v112
  v_rcp_f32 v113, v113
  v_rcp_f32 v114, v114
  v_rcp_f32 v115, v115
  v_rcp_f32 v116, v116
  v_rcp_f32 v117, v117
  v_rcp_f32 v118, v118
  v_rcp_f32 v119, v119
  v_pk_add_f32 v[40:41], v[40:41], v[112:113]
  v_pk_fma_f32 v[32:33], v[112:113], v[104:105], v[32:33]
  v_pk_add_f32 v[42:43], v[42:43], v[114:115]
  v_pk_fma_f32 v[34:35], v[114:115], v[106:107], v[34:35]
  v_pk_add_f32 v[44:45], v[44:45], v[116:117]
  v_pk_fma_f32 v[36:37], v[116:117], v[108:109], v[36:37]
  v_pk_add_f32 v[46:47], v[46:47], v[118:119]
  v_pk_fma_f32 v[38:39], v[118:119], v[110:111], v[38:39]
  s_mov_b32 s97, 0
L_epi:
  s_cmp_eq_u32 s46, -1
  s_cbranch_scc1 L_nonext2_88
  s_waitcnt lgkmcnt(0)
  v_readfirstlane_b32 s14, v180
  v_lshl_add_u32 v214, v178, 8, v210
  v_xor_b32 v215, v179, v211
  v_xor_b32 v217, 64, v215
  ds_read_b128 v[182:185], v214
  ds_read_b128 v[186:189], v214 offset:128
  ds_read_b64 v[190:191], v215 offset:4096
  ds_read_b64 v[192:193], v217 offset:4096
L_nonext2_88:
  s_mov_b32 s92, 0x358637bd
  s_mov_b32 s93, 0x358637bd
  v_pk_add_f32 v[40:41], v[40:41], s[92:93]
  v_pk_add_f32 v[42:43], v[42:43], s[92:93]
  v_pk_add_f32 v[44:45], v[44:45], s[92:93]
  v_pk_add_f32 v[46:47], v[46:47], s[92:93]
  v_rcp_f32 v40, v40
  v_rcp_f32 v41, v41
  v_rcp_f32 v42, v42
  v_rcp_f32 v43, v43
  v_rcp_f32 v44, v44
  v_rcp_f32 v45, v45
  v_rcp_f32 v46, v46
  v_rcp_f32 v47, v47
  s_nop 0
  v_pk_fma_f32 v[194:195], v[32:33], v[40:41], v[194:195]
  v_pk_fma_f32 v[196:197], v[34:35], v[42:43], v[196:197]
  v_pk_fma_f32 v[198:199], v[36:37], v[44:45], v[198:199]
  v_pk_fma_f32 v[200:201], v[38:39], v[46:47], v[200:201]
  v_max_f32 v194, 0, v194
  v_max_f32 v195, 0, v195
  v_max_f32 v196, 0, v196
  v_max_f32 v197, 0, v197
  v_max_f32 v198, 0, v198
  v_max_f32 v199, 0, v199
  v_max_f32 v200, 0, v200
  v_max_f32 v201, 0, v201
  v_pk_add_f32 v[194:195], v[194:195], v[202:203]
  v_pk_add_f32 v[196:197], v[196:197], v[204:205]
  v_pk_add_f32 v[198:199], v[198:199], v[206:207]
  v_pk_add_f32 v[200:201], v[200:201], v[208:209]
  v_cvt_pk_bf16_f32 v194, v194, v195
  v_cvt_pk_bf16_f32 v195, v196, v197
  v_cvt_pk_bf16_f32 v196, v198, v199
  v_cvt_pk_bf16_f32 v197, v200, v201
  buffer_store_dwordx2 v[194:195], v181, s[88:91], 0 offen
  buffer_store_dwordx2 v[196:197], v181, s[88:91], 0 offen offset:64
  s_cmp_eq_u32 s46, -1
  s_cbranch_scc1 L_done
  s_mov_b32 s46, s13
  s_mov_b32 s13, -1
  s_branch L_group
L_done:
  s_endpgm
L_codeend:
L_fallback:
  v_lshlrev_b32 v5, 2, v1
  s_lshl_b32 s92, s41, 7
  v_lshlrev_b32 v6, 1, v1
  v_add_u32 v6, s92, v6
  s_mov_b32 s64, s28
  s_mov_b32 s65, s29
  s_mov_b32 s66, 512
  s_mov_b32 s67, 0x20000
  buffer_load_ushort v14, v6, s[64:67], 0 offen
  s_waitcnt vmcnt(0)
  v_lshlrev_b32 v14, 16, v14
  v_mul_f32 v14, 0xbfb8aa3b, v14
  s_mov_b32 s46, s40
L_fb_node:
  s_cmp_ge_u32 s46, s45
  s_cbranch_scc1 L_fb_end
  s_lshl_b32 s92, s46, 8
  s_add_u32 s92, s92, 86016
  v_add_u32 v7, s92, v5
  ds_read_b32 v8, v7
  s_waitcnt lgkmcnt(0)
  v_lshlrev_b32 v12, 16, v8
  v_and_b32 v13, 0xffff0000, v8
  v_mov_b32 v10, 0
  v_mov_b32 v11, 0
  s_add_u32 s47, s46, s44
  s_mov_b32 s93, 0
L_fb_e:
  v_add_u32 v7, s93, v1
  v_lshlrev_b32 v8, 2, v7
  v_lshlrev_b32 v7, 1, v7
  buffer_load_dword v15, v8, s[52:55], 0 offen
  buffer_load_dword v16, v8, s[56:59], 0 offen
  buffer_load_ushort v17, v7, s[60:63], 0 offen
  s_waitcnt vmcnt(0)
  v_cmp_eq_u32 vcc, s47, v15
  s_mov_b64 s[94:95], vcc
L_fb_m:
  s_cmp_eq_u64 s[94:95], 0
  s_cbranch_scc1 L_fb_next
  s_ff1_i32_b64 s96, s[94:95]
  s_bitset0_b64 s[94:95], s96
  v_readlane_b32 s97, v16, s96
  v_readlane_b32 s92, v17, s96
  s_nop 1
  s_lshl_b32 s97, s97, 8
  s_lshl_b32 s92, s92, 16
  s_nop 4
  buffer_load_dword v18, v5, s[76:79], s97 offen sc1
  s_waitcnt vmcnt(0)
  v_lshlrev_b32 v19, 16, v18
  v_and_b32 v18, 0xffff0000, v18
  v_add_f32 v19, v19, v12
  v_fmac_f32 v19, s92, v14
  v_exp_f32 v19, v19
  s_nop 0
  v_add_f32 v19, 1.0, v19
  v_rcp_f32 v19, v19
  s_nop 0
  v_add_f32 v11, v11, v19
  v_fmac_f32 v10, v19, v18
  s_branch L_fb_m
L_fb_next:
  s_add_u32 s93, s93, 64
  s_cmp_lt_u32 s93, 160000
  s_cbranch_scc1 L_fb_e
  s_mov_b32 s92, 0x358637bd
  v_add_f32 v11, s92, v11
  v_rcp_f32 v11, v11
  s_nop 0
  v_fmac_f32 v13, v10, v11
  v_max_f32 v13, 0, v13
  s_lshl_b32 s92, s47, 9
  buffer_load_ushort v18, v6, s[48:51], s92 offen
  s_waitcnt vmcnt(0)
  v_lshlrev_b32 v18, 16, v18
  v_add_f32 v13, v13, v18
  v_cvt_pk_bf16_f32 v18, v13, v13
  buffer_store_short v18, v6, s[88:91], s92 offen
  s_add_u32 s46, s46, 8
  s_branch L_fb_node
L_fb_end:
L_end:
  s_endpgm
.section .rodata,"a"
.p2align 6
.amdhsa_kernel gather_scatter__edge_featured_mpnn_gatedgcn__graph_kernel
  .amdhsa_next_free_vgpr 256
  .amdhsa_next_free_sgpr 102
  .amdhsa_accum_offset 256
  .amdhsa_group_segment_fixed_size 0
  .amdhsa_kernarg_size 96
  .amdhsa_user_sgpr_count 2
  .amdhsa_user_sgpr_kernarg_segment_ptr 1
  .amdhsa_system_sgpr_workgroup_id_x 1
.end_amdhsa_kernel
```
